```python
import torch

def _softmax(x, axis=-1):
    return torch.softmax(x, dim=axis)
def _gelu(x):
    return torch.nn.functional.gelu(x, approximate="tanh")
def _silu(x):
    return torch.nn.functional.silu(x)
def _sigmoid(x):
    return torch.sigmoid(x)
def _layernorm(x, axis=-1, eps=1e-5):
    m = x.mean(dim=axis, keepdim=True)
    v = x.var(dim=axis, keepdim=True, unbiased=False)
    return (x - m) / torch.sqrt(v + eps)
def _scatter_add(tgt, idx, src, axis=0):
    return tgt.clone().index_add_(axis, idx, src)
def _segment_sum(src, seg, n):
    out = torch.zeros((n,) + src.shape[1:], dtype=src.dtype)
    return out.index_add_(0, seg, src)
def _pad(x, pw):
    flat = tuple(v for pair in reversed(pw) for v in pair)
    return torch.nn.functional.pad(x, flat)

kernel_name = 'standalone__mpnn_edge_mlp__graph'

def setup_inputs():

    _w = (lambda a: (lambda t: t.to(torch.bfloat16) if t.is_floating_point() else t)(torch.as_tensor(a)))
    N, deg, D, De = 25000, 32, 64, max(16, 1)
    E = N * deg
    return {
        "x": _w((lambda *s: torch.randn(*s, dtype=torch.bfloat16) * 0.05)(N, D)),
        "e_attr": _w((lambda *s: torch.randn(*s, dtype=torch.bfloat16) * 0.4)(E, De)),
        "src": _w((lambda lo, hi, *s: torch.randint(lo, hi, s))(0, N, E).to(torch.int64)),
        "dst": _w((lambda lo, hi, *s: torch.randint(lo, hi, s))(0, N, E).to(torch.int64)),
        "w_msg": _w((lambda *s: torch.randn(*s, dtype=torch.bfloat16) * 0.4)(2 * D + De, D)),
        "w_upd": _w((lambda *s: torch.randn(*s, dtype=torch.bfloat16) * 0.05)(2 * D, D)),
    }

def reference(x, e_attr, src, dst, w_msg, w_upd):
    N, D = x.shape
    m_in = torch.concatenate([x[src], x[dst], e_attr], axis=-1)
    msg = _silu(m_in @ w_msg)
    agg = _segment_sum(msg, dst, N)
    return _silu(torch.concatenate([x, agg], axis=-1) @ w_upd)
```

```asm
; @launch grid=(256,1,1) block=(512,1,1) lds=162880
.amdgcn_target "amdgcn-amd-amdhsa--gfx950"
.text
.globl standalone__mpnn_edge_mlp__graph_kernel
.p2align 8
.type standalone__mpnn_edge_mlp__graph_kernel,@function
standalone__mpnn_edge_mlp__graph_kernel:
    s_cmp_ge_u32 s2, 256
    s_cbranch_scc1 K2_end
    s_load_dwordx8 s[72:79], s[0:1], 16
    s_load_dwordx4 s[4:7], s[0:1], 0
    s_load_dwordx4 s[80:83], s[0:1], 48
    s_load_dwordx2 s[10:11], s[0:1], 64
    v_and_b32 v1, 63, v0
    v_lshrrev_b32 v3, 6, v0
    v_lshlrev_b32 v2, 4, v1
    v_readfirstlane_b32 s36, v3
    s_and_b32 s41, s2, 7
    s_lshl_b32 s41, s41, 5
    s_lshr_b32 s38, s2, 3
    s_add_u32 s35, s38, s41
    s_and_b32 s37, s36, 3
    s_mul_i32 s43, s37, 5184
    s_add_u32 s43, s43, 36928
    s_lshl_b32 s53, s37, 13
    s_mov_b32 s48, 0
    v_lshlrev_b32 v204, 2, v0
    v_lshlrev_b32 v205, 4, v0
    v_lshlrev_b32 v208, 3, v0
    v_mov_b32 v210, 0
    v_mov_b32 v211, 0
    ds_write_b64 v208, v[210:211] offset:36928
    ds_write_b64 v210, v[210:211] offset:32808
    s_mul_i32 s41, s2, 3136
    s_sub_u32 s33, 800000, s41
    s_min_u32 s33, s33, 3136
    s_lshl_b32 s41, s41, 2
    s_lshl_b32 s42, s33, 2
    s_mov_b32 s58, 8192
    s_mov_b32 s59, 10496
    s_waitcnt lgkmcnt(0)
    s_add_u32 s12, s74, s41
    s_addc_u32 s13, s75, 0
    s_mov_b32 s14, s42
    s_mov_b32 s15, 0x20000
    buffer_load_dwordx4 v[168:171], v205, s[12:15], 0 offen nt
    buffer_load_dwordx2 v[172:173], v208, s[12:15], s58 offen nt
    s_add_u32 s16, s72, s41
    s_addc_u32 s17, s73, 0
    s_mov_b32 s18, s42
    s_mov_b32 s19, 0x20000
    s_cmp_lg_u32 s36, 7
    s_cbranch_scc1 KS_noc
    buffer_load_dword v174, v204, s[12:15], s59 offen nt
    buffer_load_dword v182, v204, s[16:19], s59 offen nt
KS_noc:
    buffer_load_dwordx4 v[176:179], v205, s[16:19], 0 offen nt
    buffer_load_dwordx2 v[180:181], v208, s[16:19], s58 offen nt
    s_mul_i32 s32, s37, 10752
    s_add_u32 s32, s32, 119872
    s_barrier
    s_cmp_lt_u32 s36, 4
    s_cbranch_scc1 K2_compute
    s_setprio 1
    s_mov_b32 s88, s82
    s_mov_b32 s89, s83
    s_mov_b32 s90, 256
    s_mov_b32 s91, 0x20000
    v_mov_b32 v20, 0
    s_lshl_b32 s41, s2, 3
    s_add_u32 s41, s41, s36
    s_cmp_lg_u32 s41, 4
    s_cbranch_scc1 KS_notag
    s_memrealtime s[70:71]
    s_waitcnt lgkmcnt(0)
    s_mul_i32 s70, s70, 0x9e3779b1
    s_or_b32 s70, s70, 0x1000
    v_mov_b32 v21, s70
    buffer_store_dword v21, v20, s[88:91], 0 offen sc1
KS_notag:
    s_add_u32 s20, s10, 8388608
    s_addc_u32 s21, s11, 8388608
    s_mov_b32 s22, 25000
    s_mov_b32 s23, 0x20000
    v_mov_b32 v88, 0
    v_mov_b32 v89, 0
    v_mov_b32 v90, 0
    v_mov_b32 v91, 0
    v_lshlrev_b32 v18, 6, v1
    v_add_u32 v18, s32, v18
    v_lshl_add_u32 v120, v1, 2, s32
    v_mov_b32 v92, 0x3f80
    v_and_b32 v20, 3, v1
    v_bfe_u32 v21, v1, 4, 1
    v_lshl_or_b32 v20, v21, 2, v20
    v_lshlrev_b32 v77, 4, v20
    v_lshlrev_b32 v79, 4, v20
    v_lshlrev_b32 v81, 4, v20
    v_lshlrev_b32 v83, 4, v20
    v_and_b32 v85, 16, v2
    v_lshlrev_b32 v101, 4, v20
    v_lshlrev_b32 v103, 4, v20
    v_lshlrev_b32 v105, 4, v20
    v_lshlrev_b32 v107, 4, v20
    v_and_b32 v109, 16, v2
    v_and_b32 v20, 31, v1
    v_lshrrev_b32 v21, 4, v20
    v_lshlrev_b32 v96, 10, v21
    v_bfe_u32 v21, v20, 2, 1
    v_lshl_or_b32 v96, v21, 9, v96
    v_and_b32 v21, 3, v20
    v_lshl_or_b32 v96, v21, 1, v96
    v_and_b32 v21, 8, v20
    v_or_b32 v96, v96, v21
    v_lshl_or_b32 v96, v20, 20, v96
    s_mul_i32 s41, s53, 0x10001
    s_add_u32 s41, s41, 2048
    v_add_u32 v96, s41, v96
    v_lshl_add_u32 v97, v1, 1, s32
    v_lshl_add_u32 v98, v1, 2, s32
    s_lshl_b32 s41, s37, 2
    v_add_u32 v99, s41, v2
    s_mov_b32 s64, 0xe7fff
    s_mov_b32 s65, 0x20010
    s_mov_b32 s66, 0x3e0000
    s_mov_b32 s68, 3136
    s_cmp_lt_u32 s36, 0
    s_cselect_b32 s3, 0x10001, 1
    v_mov_b32 v206, s3
    v_mov_b32 v207, 127
    v_cmp_gt_u32 s[24:25], s33, v204
    v_lshrrev_b32 v209, 1, v204
    v_add_u32 v209, 2048, v209
    v_cmp_gt_u32 s[26:27], s33, v209
    v_add_u32 v210, 3072, v1
    s_cmp_eq_u32 s36, 7
    s_cselect_b32 s41, s33, 0
    v_cmp_gt_u32 s[28:29], s41, v210
    s_mov_b32 s30, 10995117
    s_mov_b32 s31, 3125
    v_mov_b32 v211, 1
    s_waitcnt vmcnt(2)
    s_load_dword s63, s[82:83], 0
    s_mov_b64 exec, s[24:25]
    v_lshlrev_b32 v184, 4, v168
    v_mul_hi_u32_u24 v212, s30, v184
    v_lshlrev_b32 v184, 2, v212
    ds_add_rtn_u32 v192, v184, v206 offset:36928
    v_lshlrev_b32 v185, 4, v169
    v_mul_hi_u32_u24 v213, s30, v185
    v_lshlrev_b32 v185, 2, v213
    ds_add_rtn_u32 v193, v185, v206 offset:36928
    v_lshlrev_b32 v186, 4, v170
    v_mul_hi_u32_u24 v214, s30, v186
    v_lshlrev_b32 v186, 2, v214
    ds_add_rtn_u32 v194, v186, v206 offset:36928
    v_lshlrev_b32 v187, 4, v171
    v_mul_hi_u32_u24 v215, s30, v187
    v_lshlrev_b32 v187, 2, v215
    ds_add_rtn_u32 v195, v187, v206 offset:36928
    s_mov_b64 exec, s[26:27]
    v_lshlrev_b32 v188, 4, v172
    v_mul_hi_u32_u24 v216, s30, v188
    v_lshlrev_b32 v188, 2, v216
    ds_add_rtn_u32 v196, v188, v211 offset:36928
    v_lshlrev_b32 v189, 4, v173
    v_mul_hi_u32_u24 v217, s30, v189
    v_lshlrev_b32 v189, 2, v217
    ds_add_rtn_u32 v197, v189, v211 offset:36928
    s_mov_b64 exec, s[28:29]
    v_lshlrev_b32 v190, 4, v174
    v_mul_hi_u32_u24 v218, s30, v190
    v_lshlrev_b32 v190, 2, v218
    ds_add_rtn_u32 v198, v190, v211 offset:36928
    s_mov_b64 exec, -1
    s_waitcnt vmcnt(0)
    v_mad_u32_u24 v212, v212, s31, v207
    v_lshrrev_b32 v212, 7, v212
    v_sub_u32 v212, v168, v212
    v_lshl_or_b32 v176, v212, 15, v176
    v_add_u32 v212, 0, v204
    v_lshl_or_b32 v176, v212, 20, v176
    v_mad_u32_u24 v213, v213, s31, v207
    v_lshrrev_b32 v213, 7, v213
    v_sub_u32 v213, v169, v213
    v_lshl_or_b32 v177, v213, 15, v177
    v_add_u32 v213, 1, v204
    v_lshl_or_b32 v177, v213, 20, v177
    v_mad_u32_u24 v214, v214, s31, v207
    v_lshrrev_b32 v214, 7, v214
    v_sub_u32 v214, v170, v214
    v_lshl_or_b32 v178, v214, 15, v178
    v_add_u32 v214, 2, v204
    v_lshl_or_b32 v178, v214, 20, v178
    v_mad_u32_u24 v215, v215, s31, v207
    v_lshrrev_b32 v215, 7, v215
    v_sub_u32 v215, v171, v215
    v_lshl_or_b32 v179, v215, 15, v179
    v_add_u32 v215, 3, v204
    v_lshl_or_b32 v179, v215, 20, v179
    v_mad_u32_u24 v216, v216, s31, v207
    v_lshrrev_b32 v216, 7, v216
    v_sub_u32 v216, v172, v216
    v_lshl_or_b32 v180, v216, 15, v180
    v_add_u32 v216, 0, v209
    v_lshl_or_b32 v180, v216, 20, v180
    v_mad_u32_u24 v217, v217, s31, v207
    v_lshrrev_b32 v217, 7, v217
    v_sub_u32 v217, v173, v217
    v_lshl_or_b32 v181, v217, 15, v181
    v_add_u32 v217, 1, v209
    v_lshl_or_b32 v181, v217, 20, v181
    v_mad_u32_u24 v218, v218, s31, v207
    v_lshrrev_b32 v218, 7, v218
    v_sub_u32 v218, v174, v218
    v_lshl_or_b32 v182, v218, 15, v182
    v_add_u32 v218, 0, v210
    v_lshl_or_b32 v182, v218, 20, v182
    s_waitcnt lgkmcnt(0)
    s_barrier
    s_lshl_b32 s41, s37, 10
    v_add_u32 v20, s41, v2
    ds_read_b128 v[128:131], v20 offset:36928
    ds_read_b128 v[132:135], v2 offset:36928
    ds_read_b128 v[136:139], v2 offset:37952
    ds_read_b128 v[140:143], v2 offset:38976
    s_cmp_gt_u32 s37, 0
    s_cselect_b32 s70, -1, 0
    s_cmp_gt_u32 s37, 1
    s_cselect_b32 s71, -1, 0
    s_cmp_gt_u32 s37, 2
    s_cselect_b32 s72, -1, 0
    s_waitcnt lgkmcnt(3)
    v_add_u32 v22, v128, v129
    v_add_u32 v23, v22, v130
    v_add_u32 v24, v23, v131
    s_waitcnt lgkmcnt(0)
    v_add3_u32 v132, v132, v133, v134
    v_add_u32 v132, v132, v135
    v_and_b32 v132, s70, v132
    v_add3_u32 v136, v136, v137, v138
    v_add_u32 v136, v136, v139
    v_and_b32 v136, s71, v136
    v_add3_u32 v140, v140, v141, v142
    v_add_u32 v140, v140, v143
    v_and_b32 v140, s72, v140
    v_add3_u32 v132, v132, v136, v140
    v_mov_b32 v25, v24
    s_nop 0
    v_add_u32_dpp v132, v132, v132 row_shr:1 row_mask:0xf bank_mask:0xf bound_ctrl:0
    v_add_u32_dpp v25, v25, v25 row_shr:1 row_mask:0xf bank_mask:0xf bound_ctrl:0
    s_nop 0
    v_add_u32_dpp v132, v132, v132 row_shr:2 row_mask:0xf bank_mask:0xf bound_ctrl:0
    v_add_u32_dpp v25, v25, v25 row_shr:2 row_mask:0xf bank_mask:0xf bound_ctrl:0
    s_nop 0
    v_add_u32_dpp v132, v132, v132 row_shr:4 row_mask:0xf bank_mask:0xf bound_ctrl:0
    v_add_u32_dpp v25, v25, v25 row_shr:4 row_mask:0xf bank_mask:0xf bound_ctrl:0
    s_nop 0
    v_add_u32_dpp v132, v132, v132 row_shr:8 row_mask:0xf bank_mask:0xf bound_ctrl:0
    v_add_u32_dpp v25, v25, v25 row_shr:8 row_mask:0xf bank_mask:0xf bound_ctrl:0
    s_nop 0
    v_add_u32_dpp v132, v132, v132 row_bcast:15 row_mask:0xa bank_mask:0xf
    v_add_u32_dpp v25, v25, v25 row_bcast:15 row_mask:0xa bank_mask:0xf
    s_nop 0
    v_add_u32_dpp v132, v132, v132 row_bcast:31 row_mask:0xc bank_mask:0xf
    v_add_u32_dpp v25, v25, v25 row_bcast:31 row_mask:0xc bank_mask:0xf
    v_readlane_b32 s42, v132, 63
    v_sub_u32 v25, v25, v24
    s_nop 0
    v_add_u32 v132, s42, v25
    v_add_u32 v133, v132, v128
    v_add_u32 v134, v132, v22
    v_add_u32 v135, v132, v23
    ds_write_b128 v20, v[132:135] offset:53568
    s_waitcnt lgkmcnt(0)
    s_barrier
    s_mov_b64 exec, s[24:25]
    ds_read_b32 v184, v184 offset:53568
    ds_read_b32 v185, v185 offset:53568
    ds_read_b32 v186, v186 offset:53568
    ds_read_b32 v187, v187 offset:53568
    s_mov_b64 exec, s[26:27]
    ds_read_b32 v188, v188 offset:53568
    ds_read_b32 v189, v189 offset:53568
    s_mov_b64 exec, s[28:29]
    ds_read_b32 v190, v190 offset:53568
    s_mov_b64 exec, -1
    v_and_b32 v132, 0xffff, v132
    v_lshl_or_b32 v128, v128, 16, v132
    v_and_b32 v133, 0xffff, v133
    v_lshl_or_b32 v129, v129, 16, v133
    v_and_b32 v134, 0xffff, v134
    v_lshl_or_b32 v130, v130, 16, v134
    v_and_b32 v135, 0xffff, v135
    v_lshl_or_b32 v131, v131, 16, v135
    s_mov_b32 s75, 262144
    s_add_u32 s12, s10, 4194304
    s_addc_u32 s13, s11, 0
    s_mov_b32 s14, 1048576
    s_mov_b32 s15, 0x20000
KS_tag:
    s_sub_u32 s75, s75, 1
    s_cbranch_scc1 KS_tag_ok
    s_cmp_lg_u32 s63, 0
    s_cbranch_scc1 KS_tag_ok
    buffer_load_dword v27, v88, s[88:91], 0 offen sc1
    s_waitcnt vmcnt(0)
    v_readfirstlane_b32 s63, v27
    s_branch KS_tag
KS_tag_ok:
    v_mov_b32 v27, s63
    s_lshl_b32 s70, s63, 0
    s_and_b32 s70, s70, 0xf000f000
    v_or_b32 v128, s70, v128
    s_lshl_b32 s71, s63, 4
    s_and_b32 s71, s71, 0xf000f000
    v_or_b32 v129, s71, v129
    s_lshl_b32 s72, s63, 8
    s_and_b32 s72, s72, 0xf000f000
    v_or_b32 v130, s72, v130
    s_lshl_b32 s73, s63, 12
    s_and_b32 s73, s73, 0xf000f000
    v_or_b32 v131, s73, v131
    s_lshl_b32 s41, s2, 12
    buffer_store_dwordx4 v[128:131], v20, s[12:15], s41 offen sc1
    ds_write_b32 v88, v27 offset:32800
    s_waitcnt lgkmcnt(0)
    s_mov_b64 exec, s[24:25]
    v_add_lshl_u32 v184, v184, v192, 2
    ds_write_b32 v184, v176 offset:41024
    v_add_lshl_u32 v185, v185, v193, 2
    ds_write_b32 v185, v177 offset:41024
    v_add_lshl_u32 v186, v186, v194, 2
    ds_write_b32 v186, v178 offset:41024
    v_add_lshl_u32 v187, v187, v195, 2
    ds_write_b32 v187, v179 offset:41024
    s_mov_b64 exec, s[26:27]
    v_add_lshl_u32 v188, v188, v196, 2
    ds_write_b32 v188, v180 offset:41024
    v_add_lshl_u32 v189, v189, v197, 2
    ds_write_b32 v189, v181 offset:41024
    s_mov_b64 exec, s[28:29]
    v_add_lshl_u32 v190, v190, v198, 2
    ds_write_b32 v190, v182 offset:41024
    s_mov_b64 exec, -1
    s_mul_i32 s41, s2, 12800
    s_lshl_b32 s42, s33, 2
    s_add_u32 s84, s10, s41
    s_addc_u32 s85, s11, 0
    s_mov_b32 s86, s42
    s_mov_b32 s87, 0x20000
    s_add_u32 s88, s10, 5242880
    s_addc_u32 s89, s11, 0
    s_mov_b32 s90, 24576
    s_mov_b32 s91, 0x20000
    v_and_b32 v26, 0xff0, v205
    s_waitcnt lgkmcnt(0)
    s_barrier
    ds_read_b128 v[168:171], v26 offset:41024
    ds_read_b128 v[172:175], v26 offset:45120
    ds_read_b128 v[176:179], v26 offset:49216
    ds_read_b128 v[180:183], v26 offset:53312
    s_mov_b32 s41, 0
    s_waitcnt lgkmcnt(3)
    buffer_store_dwordx4 v[168:171], v26, s[84:87], s41 offen sc1
    s_mov_b32 s41, 4096
    s_waitcnt lgkmcnt(2)
    buffer_store_dwordx4 v[172:175], v26, s[84:87], s41 offen sc1
    s_mov_b32 s41, 8192
    s_waitcnt lgkmcnt(1)
    buffer_store_dwordx4 v[176:179], v26, s[84:87], s41 offen sc1
    s_mov_b32 s41, 12288
    s_waitcnt lgkmcnt(0)
    buffer_store_dwordx4 v[180:183], v26, s[84:87], s41 offen sc1
    s_mov_b32 s16, s10
    s_mov_b32 s17, s11
    s_mov_b32 s18, 3276800
    s_mov_b32 s19, 0x20000
    s_mov_b32 s24, s6
    s_or_b32 s25, s7, 2097152
    s_mov_b32 s26, 800000
    s_mov_b32 s27, 0x20000
K2_hpass:
    v_add_u32 v20, s32, v2
    ds_write_b128 v20, v[88:91] offset:0
    ds_write_b128 v20, v[88:91] offset:1024
    ds_write_b128 v20, v[88:91] offset:2048
    ds_write_b128 v20, v[88:91] offset:3072
    v_bfe_u32 v20, v1, 2, 2
    v_bfe_u32 v21, v1, 5, 1
    v_lshl_or_b32 v20, v21, 2, v20
    v_lshl_add_u32 v93, v20, 1, s32
    v_lshrrev_b32 v20, 1, v1
    v_lshl_add_u32 v94, v20, 2, s32
    v_and_b32 v20, 31, v1
    v_lshl_add_u32 v95, v20, 2, s32
    v_xor_b32 v21, 1, v21
    v_mul_u32_u24 v21, 130, v21
    v_add_u32 v95, v95, v21
    v_mov_b32 v21, 1024
    s_cmp_lg_u32 s48, 0
    s_cbranch_scc1 K2_h1
    s_lshl_b32 s76, s2, 5
    s_waitcnt vmcnt(0)
    s_mov_b64 exec, 1
    v_mov_b32 v26, 1
    ds_add_rtn_u32 v26, v88, v26 offset:32808
    s_waitcnt lgkmcnt(0)
    v_cmp_eq_u32 vcc, 3, v26
    s_and_b64 exec, exec, vcc
    s_cbranch_execz KS_sig0
    buffer_store_dword v27, v88, s[88:91], s76 offen sc1
KS_sig0:
    s_mov_b64 exec, -1
    s_barrier
K2_h1:
    ds_read_b32 v4, v99 offset:32832
    ds_read_b32 v5, v99 offset:33856
    ds_read_b32 v6, v99 offset:34880
    ds_read_b32 v7, v99 offset:35904
    v_add_u32 v22, 57664, v2
    ds_read_b128 v[112:115], v22
    s_waitcnt lgkmcnt(1)
    v_lshrrev_b32 v8, 16, v4
    v_lshrrev_b32 v9, 16, v5
    v_lshrrev_b32 v10, 16, v6
    v_lshrrev_b32 v11, 16, v7
    v_add_u32 v14, v8, v9
    v_add_u32 v15, v14, v10
    v_add_u32 v16, v15, v11
    v_mov_b32 v17, v16
    s_waitcnt lgkmcnt(0)
    v_and_b32 v4, 0xffff, v4
    v_and_b32 v5, 0xffff, v5
    v_add_u32_dpp v17, v17, v17 row_shr:1 row_mask:0xf bank_mask:0xf bound_ctrl:0
    v_and_b32 v6, 0xffff, v6
    v_and_b32 v7, 0xffff, v7
    v_add_u32_dpp v17, v17, v17 row_shr:2 row_mask:0xf bank_mask:0xf bound_ctrl:0
    v_max3_u32 v22, v112, v113, v114
    v_max_u32 v22, v22, v115
    v_add_u32_dpp v17, v17, v17 row_shr:4 row_mask:0xf bank_mask:0xf bound_ctrl:0
    v_cmp_lt_u32 vcc, 0x28ffff, v22
    s_nop 0
    v_add_u32_dpp v17, v17, v17 row_shr:8 row_mask:0xf bank_mask:0xf bound_ctrl:0
    s_or_b32 s34, vcc_lo, vcc_hi
    s_or_b32 s34, s34, s48
    v_add_u32_dpp v17, v17, v17 row_bcast:15 row_mask:0xa bank_mask:0xf
    s_cselect_b32 s58, 3200, 40
    s_cselect_b32 s59, 0, 0xffff
    v_add_u32_dpp v17, v17, v17 row_bcast:31 row_mask:0xc bank_mask:0xf
    s_mov_b32 s67, 107374183
    s_cmov_b32 s67, 1342178
    v_readlane_b32 s44, v17, 63
    s_lshl_b32 s60, s58, 2
    v_sub_u32 v12, v17, v16
    v_mul_u32_u24 v20, s60, v1
    v_add_u32 v13, v12, v8
    v_add_u32 v14, v12, v14
    v_add_u32 v15, v12, v15
    s_max_u32 s49, s44, s48
    s_sub_u32 s49, s49, s48
    v_and_b32 v112, s59, v112
    v_add_u32 v4, v4, v20
    v_add_u32 v20, s58, v20
    v_add_u32 v112, v112, v12
    v_sub_u32 v4, v4, v112
    v_subrev_u32 v12, s48, v12
    v_add_u32 v8, v8, v12
    v_med3_i32 v12, v12, 0, v21
    v_cmp_gt_i32 s[70:71], v8, v12
    v_and_b32 v113, s59, v113
    v_add_u32 v5, v5, v20
    v_add_u32 v20, s58, v20
    v_add_u32 v113, v113, v13
    v_sub_u32 v5, v5, v113
    v_subrev_u32 v13, s48, v13
    v_add_u32 v9, v9, v13
    v_med3_i32 v13, v13, 0, v21
    v_cmp_gt_i32 s[72:73], v9, v13
    v_and_b32 v114, s59, v114
    v_add_u32 v6, v6, v20
    v_add_u32 v20, s58, v20
    v_add_u32 v114, v114, v14
    v_sub_u32 v6, v6, v114
    v_subrev_u32 v14, s48, v14
    v_add_u32 v10, v10, v14
    v_med3_i32 v14, v14, 0, v21
    v_cmp_gt_i32 s[74:75], v10, v14
    v_and_b32 v115, s59, v115
    v_add_u32 v7, v7, v20
    v_add_u32 v115, v115, v15
    v_sub_u32 v7, v7, v115
    v_subrev_u32 v15, s48, v15
    v_add_u32 v11, v11, v15
    v_med3_i32 v15, v15, 0, v21
    v_cmp_gt_i32 s[76:77], v11, v15
    v_cndmask_b32 v12, v21, v12, s[70:71]
    v_lshl_add_u32 v12, v12, 2, s32
    ds_write_b32 v12, v4
    v_cndmask_b32 v13, v21, v13, s[72:73]
    v_lshl_add_u32 v13, v13, 2, s32
    ds_write_b32 v13, v5
    v_cndmask_b32 v14, v21, v14, s[74:75]
    v_lshl_add_u32 v14, v14, 2, s32
    ds_write_b32 v14, v6
    v_cndmask_b32 v15, v21, v15, s[76:77]
    v_lshl_add_u32 v15, v15, 2, s32
    ds_write_b32 v15, v7
    ds_read_b128 v[28:31], v18 offset:0
    ds_read_b128 v[32:35], v18 offset:16
    ds_read_b128 v[36:39], v18 offset:32
    ds_read_b128 v[40:43], v18 offset:48
    v_mov_b32 v22, s44
    s_lshl_b32 s41, s37, 2
    v_mov_b32 v23, s41
    ds_write_b32 v23, v22 offset:32768
    v_add_u32 v20, s48, v2
    s_max_u32 s46, s44, s48
    s_sub_u32 s46, s46, s48
    s_min_u32 s46, s46, 1024
    s_add_u32 s46, s46, 31
    s_lshr_b32 s46, s46, 5
    s_waitcnt lgkmcnt(1)
    v_max3_u32 v17, v28, v29, v30
    v_max3_u32 v17, v17, v31, v32
    v_max3_u32 v17, v17, v33, v34
    v_max3_u32 v17, v17, v35, v36
    v_max3_u32 v17, v17, v37, v38
    v_max3_u32 v17, v17, v39, v40
    v_max3_u32 v17, v17, v41, v42
    v_max_u32 v17, v17, v43
    v_max_u32 v29, v29, v28
    v_max_u32 v30, v30, v29
    v_max_u32_dpp v17, v17, v17 row_shr:1 row_mask:0xf bank_mask:0xf bound_ctrl:0
    v_max_u32 v31, v31, v30
    v_max_u32 v32, v32, v31
    v_max_u32_dpp v17, v17, v17 row_shr:2 row_mask:0xf bank_mask:0xf bound_ctrl:0
    v_max_u32 v33, v33, v32
    v_max_u32 v34, v34, v33
    v_max_u32_dpp v17, v17, v17 row_shr:4 row_mask:0xf bank_mask:0xf bound_ctrl:0
    v_max_u32 v35, v35, v34
    v_max_u32 v36, v36, v35
    v_max_u32_dpp v17, v17, v17 row_shr:8 row_mask:0xf bank_mask:0xf bound_ctrl:0
    v_max_u32 v37, v37, v36
    v_max_u32 v38, v38, v37
    v_max_u32_dpp v17, v17, v17 row_bcast:15 row_mask:0xa bank_mask:0xf
    v_max_u32 v39, v39, v38
    v_max_u32 v40, v40, v39
    v_max_u32_dpp v17, v17, v17 row_bcast:31 row_mask:0xc bank_mask:0xf
    v_max_u32 v41, v41, v40
    v_max_u32 v42, v42, v41
    v_mov_b32_dpp v16, v17 wave_shr:1 row_mask:0xf bank_mask:0xf bound_ctrl:0
    v_max_u32 v43, v43, v42
    v_max_u32 v28, v28, v16
    v_add3_u32 v28, v28, v20, 0
    v_max_u32 v29, v29, v16
    v_add3_u32 v29, v29, v20, 1
    v_max_u32 v30, v30, v16
    v_add3_u32 v30, v30, v20, 2
    v_max_u32 v31, v31, v16
    v_add3_u32 v31, v31, v20, 3
    ds_write_b128 v18, v[28:31] offset:0
    v_max_u32 v32, v32, v16
    v_add3_u32 v32, v32, v20, 4
    v_max_u32 v33, v33, v16
    v_add3_u32 v33, v33, v20, 5
    v_max_u32 v34, v34, v16
    v_add3_u32 v34, v34, v20, 6
    v_max_u32 v35, v35, v16
    v_add3_u32 v35, v35, v20, 7
    ds_write_b128 v18, v[32:35] offset:16
    v_max_u32 v36, v36, v16
    v_add3_u32 v36, v36, v20, 8
    v_max_u32 v37, v37, v16
    v_add3_u32 v37, v37, v20, 9
    v_max_u32 v38, v38, v16
    v_add3_u32 v38, v38, v20, 10
    v_max_u32 v39, v39, v16
    v_add3_u32 v39, v39, v20, 11
    ds_write_b128 v18, v[36:39] offset:32
    v_max_u32 v40, v40, v16
    v_add3_u32 v40, v40, v20, 12
    v_max_u32 v41, v41, v16
    v_add3_u32 v41, v41, v20, 13
    v_max_u32 v42, v42, v16
    v_add3_u32 v42, v42, v20, 14
    v_max_u32 v43, v43, v16
    v_add3_u32 v43, v43, v20, 15
    ds_write_b128 v18, v[40:43] offset:48
    ds_read2st64_b32 v[44:45], v120 offset0:0 offset1:1
    ds_read2st64_b32 v[46:47], v120 offset0:2 offset1:3
    ds_read2st64_b32 v[48:49], v120 offset0:4 offset1:5
    ds_read2st64_b32 v[50:51], v120 offset0:6 offset1:7
    ds_read2st64_b32 v[52:53], v120 offset0:8 offset1:9
    ds_read2st64_b32 v[54:55], v120 offset0:10 offset1:11
    ds_read2st64_b32 v[56:57], v120 offset0:12 offset1:13
    ds_read2st64_b32 v[58:59], v120 offset0:14 offset1:15
    s_cmp_lg_u32 s34, 0
    s_cselect_b32 s60, 0, 78400
    s_sub_u32 s41, s49, 1
    v_sub_u32 v17, s41, v1
    s_waitcnt lgkmcnt(7)
    v_lshl_add_u32 v28, v44, 2, s60
    v_lshl_add_u32 v29, v45, 2, s60
    s_waitcnt lgkmcnt(6)
    v_lshl_add_u32 v30, v46, 2, s60
    v_lshl_add_u32 v31, v47, 2, s60
    s_waitcnt lgkmcnt(5)
    v_lshl_add_u32 v32, v48, 2, s60
    v_lshl_add_u32 v33, v49, 2, s60
    s_waitcnt lgkmcnt(4)
    v_lshl_add_u32 v34, v50, 2, s60
    v_lshl_add_u32 v35, v51, 2, s60
    s_waitcnt lgkmcnt(3)
    v_lshl_add_u32 v36, v52, 2, s60
    v_lshl_add_u32 v37, v53, 2, s60
    s_waitcnt lgkmcnt(2)
    v_lshl_add_u32 v38, v54, 2, s60
    v_lshl_add_u32 v39, v55, 2, s60
    s_waitcnt lgkmcnt(1)
    v_lshl_add_u32 v40, v56, 2, s60
    v_lshl_add_u32 v41, v57, 2, s60
    s_waitcnt lgkmcnt(0)
    v_lshl_add_u32 v42, v58, 2, s60
    v_lshl_add_u32 v43, v59, 2, s60
    v_mul_hi_u32 v44, v44, s67
    v_mul_hi_u32 v45, v45, s67
    v_mul_hi_u32 v46, v46, s67
    v_mul_hi_u32 v47, v47, s67
    v_mul_hi_u32 v48, v48, s67
    v_mul_hi_u32 v49, v49, s67
    v_mul_hi_u32 v50, v50, s67
    v_mul_hi_u32 v51, v51, s67
    v_mul_hi_u32 v52, v52, s67
    v_mul_hi_u32 v53, v53, s67
    v_mul_hi_u32 v54, v54, s67
    v_mul_hi_u32 v55, v55, s67
    v_mul_hi_u32 v56, v56, s67
    v_mul_hi_u32 v57, v57, s67
    v_mul_hi_u32 v58, v58, s67
    v_mul_hi_u32 v59, v59, s67
    s_barrier
    s_cmp_lg_u32 s34, 0
    s_cbranch_scc1 K2_hglob
    ds_read_b32 v60, v28
    ds_read_b32 v61, v29
    ds_read_b32 v62, v30
    ds_read_b32 v63, v31
    ds_read_b32 v64, v32
    ds_read_b32 v65, v33
    ds_read_b32 v66, v34
    ds_read_b32 v67, v35
    ds_read_b32 v68, v36
    ds_read_b32 v69, v37
    ds_read_b32 v70, v38
    ds_read_b32 v71, v39
    ds_read_b32 v72, v40
    ds_read_b32 v73, v41
    ds_read_b32 v74, v42
    s_waitcnt lgkmcnt(12)
    ds_read_b32 v75, v43
    s_branch K2_h3
K2_hglob:
    buffer_load_dword v60, v28, s[16:19], 0 offen sc1
    buffer_load_dword v61, v29, s[16:19], 0 offen sc1
    buffer_load_dword v62, v30, s[16:19], 0 offen sc1
    buffer_load_dword v63, v31, s[16:19], 0 offen sc1
    buffer_load_dword v64, v32, s[16:19], 0 offen sc1
    buffer_load_dword v65, v33, s[16:19], 0 offen sc1
    buffer_load_dword v66, v34, s[16:19], 0 offen sc1
    buffer_load_dword v67, v35, s[16:19], 0 offen sc1
    buffer_load_dword v68, v36, s[16:19], 0 offen sc1
    buffer_load_dword v69, v37, s[16:19], 0 offen sc1
    buffer_load_dword v70, v38, s[16:19], 0 offen sc1
    buffer_load_dword v71, v39, s[16:19], 0 offen sc1
    buffer_load_dword v72, v40, s[16:19], 0 offen sc1
    buffer_load_dword v73, v41, s[16:19], 0 offen sc1
    buffer_load_dword v74, v42, s[16:19], 0 offen sc1
    buffer_load_dword v75, v43, s[16:19], 0 offen sc1
    s_waitcnt vmcnt(0)
K2_h3:
    v_ashrrev_i32 v20, 31, v17
    v_bfi_b32 v60, v20, s64, v60
    v_and_b32 v21, 0x7fff, v60
    ds_write_b16 v97, v21 offset:0
    v_lshrrev_b32 v23, 20, v60
    v_mad_u32_u24 v22, v44, s68, v23
    v_or_b32 v22, v22, v20
    v_bfe_u32 v24, v60, 15, 5
    v_mad_u32_u24 v25, v24, s65, v96
    v_and_b32 v24, 0x18, v24
    v_mad_u32_u24 v25, v24, s66, v25
    ds_write2st64_b32 v98, v22, v25 offset0:8 offset1:24
    s_waitcnt lgkmcnt(2)
    ds_read_u16 v76, v93 offset:0
    ds_read_u16 v78, v93 offset:16
    ds_read_u16 v80, v93 offset:32
    ds_read_u16 v82, v93 offset:48
    ds_read_b32 v84, v94 offset:2048
    ds_read_u16 v100, v93 offset:64
    ds_read_u16 v102, v93 offset:80
    ds_read_u16 v104, v93 offset:96
    ds_read_u16 v106, v93 offset:112
    ds_read_b32 v108, v94 offset:2176
    ds_read_u16 v87, v95 offset:6144
    s_waitcnt lgkmcnt(6)
    s_add_u32 m0, s43, 4160
    s_nop 0
    buffer_load_dwordx4 v[84:85], s[24:27], 0 idxen offen sc1 lds
    s_add_u32 m0, s43, 0
    s_nop 0
    buffer_load_dwordx4 v[76:77], s[20:23], 0 idxen offen sc1 lds
    s_add_u32 m0, s43, 1040
    s_nop 0
    buffer_load_dwordx4 v[78:79], s[20:23], 0 idxen offen sc1 lds
    s_add_u32 m0, s43, 2080
    s_nop 0
    buffer_load_dwordx4 v[80:81], s[20:23], 0 idxen offen sc1 lds
    s_add_u32 m0, s43, 3120
    s_nop 0
    buffer_load_dwordx4 v[82:83], s[20:23], 0 idxen offen sc1 lds
    s_waitcnt lgkmcnt(0)
    v_mov_b32 v86, v87
    ds_write_b16 v87, v92 offset:4096
    s_mov_b32 exec_hi, 0
    ds_read_u16 v86, v95 offset:6016
    s_waitcnt lgkmcnt(0)
    ds_write_b16 v86, v92
    s_mov_b32 exec_hi, -1
    v_add_u32 v20, 101188032, v96
    ds_write2st64_b32 v98, v20, v20 offset0:40 offset1:41
    s_add_u32 s41, s49, 192
    v_subrev_u32 v17, 64, v17
    v_ashrrev_i32 v20, 31, v17
    v_bfi_b32 v61, v20, s64, v61
    v_and_b32 v21, 0x7fff, v61
    ds_write_b16 v97, v21 offset:128
    v_lshrrev_b32 v23, 20, v61
    v_mad_u32_u24 v22, v45, s68, v23
    v_or_b32 v22, v22, v20
    v_bfe_u32 v24, v61, 15, 5
    v_mad_u32_u24 v25, v24, s65, v96
    v_and_b32 v24, 0x18, v24
    v_mad_u32_u24 v25, v24, s66, v25
    ds_write2st64_b32 v98, v22, v25 offset0:9 offset1:25
    s_add_u32 m0, s43, 24896
    s_nop 0
    buffer_load_dwordx4 v[108:109], s[24:27], 0 idxen offen sc1 nt lds
    s_add_u32 m0, s43, 20736
    s_nop 0
    buffer_load_dwordx4 v[100:101], s[20:23], 0 idxen offen sc1 lds
    s_add_u32 m0, s43, 21776
    s_nop 0
    buffer_load_dwordx4 v[102:103], s[20:23], 0 idxen offen sc1 lds
    s_add_u32 m0, s43, 22816
    s_nop 0
    buffer_load_dwordx4 v[104:105], s[20:23], 0 idxen offen sc1 lds
    s_add_u32 m0, s43, 23856
    s_nop 0
    buffer_load_dwordx4 v[106:107], s[20:23], 0 idxen offen sc1 lds
    v_subrev_u32 v17, 64, v17
    v_ashrrev_i32 v20, 31, v17
    v_bfi_b32 v62, v20, s64, v62
    v_and_b32 v21, 0x7fff, v62
    ds_write_b16 v97, v21 offset:256
    v_lshrrev_b32 v23, 20, v62
    v_mad_u32_u24 v22, v46, s68, v23
    v_or_b32 v22, v22, v20
    v_bfe_u32 v24, v62, 15, 5
    v_mad_u32_u24 v25, v24, s65, v96
    v_and_b32 v24, 0x18, v24
    v_mad_u32_u24 v25, v24, s66, v25
    ds_write2st64_b32 v98, v22, v25 offset0:10 offset1:26
    v_subrev_u32 v17, 64, v17
    v_ashrrev_i32 v20, 31, v17
    v_bfi_b32 v63, v20, s64, v63
    v_and_b32 v21, 0x7fff, v63
    ds_write_b16 v97, v21 offset:384
    v_lshrrev_b32 v23, 20, v63
    v_mad_u32_u24 v22, v47, s68, v23
    v_or_b32 v22, v22, v20
    v_bfe_u32 v24, v63, 15, 5
    v_mad_u32_u24 v25, v24, s65, v96
    v_and_b32 v24, 0x18, v24
    v_mad_u32_u24 v25, v24, s66, v25
    ds_write2st64_b32 v98, v22, v25 offset0:11 offset1:27
    v_subrev_u32 v17, 64, v17
    v_ashrrev_i32 v20, 31, v17
    v_bfi_b32 v64, v20, s64, v64
    v_and_b32 v21, 0x7fff, v64
    ds_write_b16 v97, v21 offset:512
    v_lshrrev_b32 v23, 20, v64
    v_mad_u32_u24 v22, v48, s68, v23
    v_or_b32 v22, v22, v20
    v_bfe_u32 v24, v64, 15, 5
    v_mad_u32_u24 v25, v24, s65, v96
    v_and_b32 v24, 0x18, v24
    v_mad_u32_u24 v25, v24, s66, v25
    ds_write2st64_b32 v98, v22, v25 offset0:12 offset1:28
    v_subrev_u32 v17, 64, v17
    v_ashrrev_i32 v20, 31, v17
    v_bfi_b32 v65, v20, s64, v65
    v_and_b32 v21, 0x7fff, v65
    ds_write_b16 v97, v21 offset:640
    v_lshrrev_b32 v23, 20, v65
    v_mad_u32_u24 v22, v49, s68, v23
    v_or_b32 v22, v22, v20
    v_bfe_u32 v24, v65, 15, 5
    v_mad_u32_u24 v25, v24, s65, v96
    v_and_b32 v24, 0x18, v24
    v_mad_u32_u24 v25, v24, s66, v25
    ds_write2st64_b32 v98, v22, v25 offset0:13 offset1:29
    v_subrev_u32 v17, 64, v17
    v_ashrrev_i32 v20, 31, v17
    v_bfi_b32 v66, v20, s64, v66
    v_and_b32 v21, 0x7fff, v66
    ds_write_b16 v97, v21 offset:768
    v_lshrrev_b32 v23, 20, v66
    v_mad_u32_u24 v22, v50, s68, v23
    v_or_b32 v22, v22, v20
    v_bfe_u32 v24, v66, 15, 5
    v_mad_u32_u24 v25, v24, s65, v96
    v_and_b32 v24, 0x18, v24
    v_mad_u32_u24 v25, v24, s66, v25
    ds_write2st64_b32 v98, v22, v25 offset0:14 offset1:30
    v_subrev_u32 v17, 64, v17
    v_ashrrev_i32 v20, 31, v17
    v_bfi_b32 v67, v20, s64, v67
    v_and_b32 v21, 0x7fff, v67
    ds_write_b16 v97, v21 offset:896
    v_lshrrev_b32 v23, 20, v67
    v_mad_u32_u24 v22, v51, s68, v23
    v_or_b32 v22, v22, v20
    v_bfe_u32 v24, v67, 15, 5
    v_mad_u32_u24 v25, v24, s65, v96
    v_and_b32 v24, 0x18, v24
    v_mad_u32_u24 v25, v24, s66, v25
    ds_write2st64_b32 v98, v22, v25 offset0:15 offset1:31
    v_subrev_u32 v17, 64, v17
    v_ashrrev_i32 v20, 31, v17
    v_bfi_b32 v68, v20, s64, v68
    v_and_b32 v21, 0x7fff, v68
    ds_write_b16 v97, v21 offset:1024
    v_lshrrev_b32 v23, 20, v68
    v_mad_u32_u24 v22, v52, s68, v23
    v_or_b32 v22, v22, v20
    v_bfe_u32 v24, v68, 15, 5
    v_mad_u32_u24 v25, v24, s65, v96
    v_and_b32 v24, 0x18, v24
    v_mad_u32_u24 v25, v24, s66, v25
    ds_write2st64_b32 v98, v22, v25 offset0:16 offset1:32
    ds_read_u16 v76, v93 offset:128
    ds_read_u16 v78, v93 offset:144
    ds_read_u16 v80, v93 offset:160
    ds_read_u16 v82, v93 offset:176
    ds_read_b32 v84, v94 offset:2304
    v_subrev_u32 v17, 64, v17
    v_ashrrev_i32 v20, 31, v17
    v_bfi_b32 v69, v20, s64, v69
    v_and_b32 v21, 0x7fff, v69
    ds_write_b16 v97, v21 offset:1152
    v_lshrrev_b32 v23, 20, v69
    v_mad_u32_u24 v22, v53, s68, v23
    v_or_b32 v22, v22, v20
    v_bfe_u32 v24, v69, 15, 5
    v_mad_u32_u24 v25, v24, s65, v96
    v_and_b32 v24, 0x18, v24
    v_mad_u32_u24 v25, v24, s66, v25
    ds_write2st64_b32 v98, v22, v25 offset0:17 offset1:33
    s_waitcnt lgkmcnt(2)
    s_barrier
    s_add_u32 m0, s43, 45632
    s_nop 0
    buffer_load_dwordx4 v[84:85], s[24:27], 0 idxen offen sc1 lds
    s_add_u32 m0, s43, 41472
    s_nop 0
    buffer_load_dwordx4 v[76:77], s[20:23], 0 idxen offen sc1 lds
    s_add_u32 m0, s43, 42512
    s_nop 0
    buffer_load_dwordx4 v[78:79], s[20:23], 0 idxen offen sc1 lds
    s_add_u32 m0, s43, 43552
    s_nop 0
    buffer_load_dwordx4 v[80:81], s[20:23], 0 idxen offen sc1 lds
    s_add_u32 m0, s43, 44592
    s_nop 0
    buffer_load_dwordx4 v[82:83], s[20:23], 0 idxen offen sc1 lds
    s_cmp_le_u32 s41, 640
    s_cbranch_scc1 K2_hconv_done
    v_subrev_u32 v17, 64, v17
    v_ashrrev_i32 v20, 31, v17
    v_bfi_b32 v70, v20, s64, v70
    v_and_b32 v21, 0x7fff, v70
    ds_write_b16 v97, v21 offset:1280
    v_lshrrev_b32 v23, 20, v70
    v_mad_u32_u24 v22, v54, s68, v23
    v_or_b32 v22, v22, v20
    v_bfe_u32 v24, v70, 15, 5
    v_mad_u32_u24 v25, v24, s65, v96
    v_and_b32 v24, 0x18, v24
    v_mad_u32_u24 v25, v24, s66, v25
    ds_write2st64_b32 v98, v22, v25 offset0:18 offset1:34
    s_cmp_le_u32 s41, 704
    s_cbranch_scc1 K2_hconv_done
    v_subrev_u32 v17, 64, v17
    v_ashrrev_i32 v20, 31, v17
    v_bfi_b32 v71, v20, s64, v71
    v_and_b32 v21, 0x7fff, v71
    ds_write_b16 v97, v21 offset:1408
    v_lshrrev_b32 v23, 20, v71
    v_mad_u32_u24 v22, v55, s68, v23
    v_or_b32 v22, v22, v20
    v_bfe_u32 v24, v71, 15, 5
    v_mad_u32_u24 v25, v24, s65, v96
    v_and_b32 v24, 0x18, v24
    v_mad_u32_u24 v25, v24, s66, v25
    ds_write2st64_b32 v98, v22, v25 offset0:19 offset1:35
    s_cmp_le_u32 s41, 768
    s_cbranch_scc1 K2_hconv_done
    v_subrev_u32 v17, 64, v17
    v_ashrrev_i32 v20, 31, v17
    v_bfi_b32 v72, v20, s64, v72
    v_and_b32 v21, 0x7fff, v72
    ds_write_b16 v97, v21 offset:1536
    v_lshrrev_b32 v23, 20, v72
    v_mad_u32_u24 v22, v56, s68, v23
    v_or_b32 v22, v22, v20
    v_bfe_u32 v24, v72, 15, 5
    v_mad_u32_u24 v25, v24, s65, v96
    v_and_b32 v24, 0x18, v24
    v_mad_u32_u24 v25, v24, s66, v25
    ds_write2st64_b32 v98, v22, v25 offset0:20 offset1:36
    s_cmp_le_u32 s41, 832
    s_cbranch_scc1 K2_hconv_done
    v_subrev_u32 v17, 64, v17
    v_ashrrev_i32 v20, 31, v17
    v_bfi_b32 v73, v20, s64, v73
    v_and_b32 v21, 0x7fff, v73
    ds_write_b16 v97, v21 offset:1664
    v_lshrrev_b32 v23, 20, v73
    v_mad_u32_u24 v22, v57, s68, v23
    v_or_b32 v22, v22, v20
    v_bfe_u32 v24, v73, 15, 5
    v_mad_u32_u24 v25, v24, s65, v96
    v_and_b32 v24, 0x18, v24
    v_mad_u32_u24 v25, v24, s66, v25
    ds_write2st64_b32 v98, v22, v25 offset0:21 offset1:37
    s_cmp_le_u32 s41, 896
    s_cbranch_scc1 K2_hconv_done
    v_subrev_u32 v17, 64, v17
    v_ashrrev_i32 v20, 31, v17
    v_bfi_b32 v74, v20, s64, v74
    v_and_b32 v21, 0x7fff, v74
    ds_write_b16 v97, v21 offset:1792
    v_lshrrev_b32 v23, 20, v74
    v_mad_u32_u24 v22, v58, s68, v23
    v_or_b32 v22, v22, v20
    v_bfe_u32 v24, v74, 15, 5
    v_mad_u32_u24 v25, v24, s65, v96
    v_and_b32 v24, 0x18, v24
    v_mad_u32_u24 v25, v24, s66, v25
    ds_write2st64_b32 v98, v22, v25 offset0:22 offset1:38
    s_cmp_le_u32 s41, 960
    s_cbranch_scc1 K2_hconv_done
    v_subrev_u32 v17, 64, v17
    v_ashrrev_i32 v20, 31, v17
    v_bfi_b32 v75, v20, s64, v75
    v_and_b32 v21, 0x7fff, v75
    ds_write_b16 v97, v21 offset:1920
    v_lshrrev_b32 v23, 20, v75
    v_mad_u32_u24 v22, v59, s68, v23
    v_or_b32 v22, v22, v20
    v_bfe_u32 v24, v75, 15, 5
    v_mad_u32_u24 v25, v24, s65, v96
    v_and_b32 v24, 0x18, v24
    v_mad_u32_u24 v25, v24, s66, v25
    ds_write2st64_b32 v98, v22, v25 offset0:23 offset1:39
K2_hconv_done:
    ds_read_b32 v84, v94 offset:2560
    ds_read_u16 v100, v93 offset:192
    ds_read_u16 v102, v93 offset:208
    ds_read_u16 v104, v93 offset:224
    ds_read_u16 v106, v93 offset:240
    ds_read_b32 v108, v94 offset:2432
    ds_read_u16 v110, v95 offset:6272
    s_mov_b32 s50, s43
    s_add_u32 s42, s43, 82944
    v_mov_b32 v24, 0
    ds_read_b128 v[20:23], v24 offset:32768
    s_waitcnt lgkmcnt(0)
    v_max_u32 v24, v20, v21
    v_max3_u32 v24, v24, v22, v23
    s_nop 0
    v_readfirstlane_b32 s45, v24
    s_max_u32 s47, s45, s48
    s_sub_u32 s47, s47, s48
    s_min_u32 s47, s47, 1024
    s_add_u32 s47, s47, 31
    s_lshr_b32 s47, s47, 5
    s_sub_u32 s47, s47, s46
    s_waitcnt vmcnt(10)
    s_barrier
    s_cmp_eq_u32 s46, 0
    s_cbranch_scc1 K2_hrest
    s_and_b32 s41, s47, -2
    s_cbranch_scc0 K2_hpre_go
    s_sub_u32 s47, s47, s41
K2_hpre:
    s_barrier
    s_sub_u32 s41, s41, 1
    s_cmp_lg_u32 s41, 0
    s_cbranch_scc1 K2_hpre
K2_hpre_go:
    s_add_u32 s61, s43, 62208
    s_add_u32 s62, s43, 41472
    s_waitcnt vmcnt(5) lgkmcnt(0)
    s_barrier
    s_add_u32 m0, s43, 62208
    s_nop 0
    buffer_load_dwordx4 v[100:101], s[20:23], 0 idxen offen sc1 lds
    s_add_u32 m0, s43, 63248
    s_nop 0
    buffer_load_dwordx4 v[102:103], s[20:23], 0 idxen offen sc1 lds
    s_add_u32 m0, s43, 64288
    s_nop 0
    buffer_load_dwordx4 v[104:105], s[20:23], 0 idxen offen sc1 lds
    s_add_u32 m0, s43, 65328
    s_nop 0
    buffer_load_dwordx4 v[106:107], s[20:23], 0 idxen offen sc1 lds
    s_branch K2_hloopa
K2_hloop:
    s_barrier
K2_hloopa:
    ds_write_b16 v86, v88 offset:0
    ds_write_b16 v110, v92 offset:0
    v_mov_b32 v86, v110
    ds_read_u16 v110, v95 offset:6400
    ds_read_u16 v76, v93 offset:256
    ds_read_u16 v78, v93 offset:272
    ds_read_u16 v80, v93 offset:288
    ds_read_u16 v82, v93 offset:304
    ds_read_u16 v100, v93 offset:320
    ds_read_u16 v102, v93 offset:336
    ds_read_u16 v104, v93 offset:352
    ds_read_u16 v106, v93 offset:368
    s_cmp_gt_u32 s46, 9
    s_cbranch_scc1 K2_hearly
    s_add_u32 m0, s61, 4160
    s_nop 0
    buffer_load_dwordx4 v[108:109], s[24:27], 0 idxen offen sc1 lds
    s_add_u32 m0, s50, 4160
    s_nop 0
    buffer_load_dwordx4 v[84:85], s[24:27], 0 idxen offen sc1 lds
    s_branch K2_hlate
K2_hearly:
    s_add_u32 m0, s61, 4160
    s_nop 0
    buffer_load_dwordx4 v[108:109], s[24:27], 0 idxen offen sc1 nt lds
    s_add_u32 m0, s50, 4160
    s_nop 0
    buffer_load_dwordx4 v[84:85], s[24:27], 0 idxen offen sc1 lds
K2_hlate:
    s_mov_b32 s62, s61
    s_mov_b32 s61, s50
    s_add_u32 s50, s50, 20736
    s_cmp_eq_u32 s50, s42
    s_cselect_b32 s50, s43, s50
    s_sub_u32 s46, s46, 1
    s_cmp_eq_u32 s46, 0
    s_waitcnt vmcnt(6) lgkmcnt(0)
    s_cbranch_scc1 K2_hrest
    s_barrier
    ds_write_b16 v87, v88 offset:4096
    ds_write_b16 v110, v92 offset:4096
    v_mov_b32 v87, v110
    ds_read_u16 v110, v95 offset:6528
    ds_read_b32 v108, v94 offset:2688
    ds_read_b32 v84, v94 offset:2816
    s_add_u32 m0, s61, 0
    s_nop 0
    buffer_load_dwordx4 v[76:77], s[20:23], 0 idxen offen sc1 lds
    s_add_u32 m0, s61, 1040
    s_nop 0
    buffer_load_dwordx4 v[78:79], s[20:23], 0 idxen offen sc1 lds
    s_add_u32 m0, s61, 2080
    s_nop 0
    buffer_load_dwordx4 v[80:81], s[20:23], 0 idxen offen sc1 lds
    s_add_u32 m0, s61, 3120
    s_nop 0
    buffer_load_dwordx4 v[82:83], s[20:23], 0 idxen offen sc1 lds
    s_add_u32 m0, s50, 0
    s_nop 0
    buffer_load_dwordx4 v[100:101], s[20:23], 0 idxen offen sc1 lds
    s_add_u32 m0, s50, 1040
    s_nop 0
    buffer_load_dwordx4 v[102:103], s[20:23], 0 idxen offen sc1 lds
    s_add_u32 m0, s50, 2080
    s_nop 0
    buffer_load_dwordx4 v[104:105], s[20:23], 0 idxen offen sc1 lds
    s_add_u32 m0, s50, 3120
    s_nop 0
    buffer_load_dwordx4 v[106:107], s[20:23], 0 idxen offen sc1 lds
    s_mov_b32 s62, s61
    s_mov_b32 s61, s50
    s_add_u32 s50, s50, 20736
    s_cmp_eq_u32 s50, s42
    s_cselect_b32 s50, s43, s50
    v_add_u32 v93, 128, v93
    v_add_u32 v94, 256, v94
    v_add_u32 v95, 256, v95
    s_sub_u32 s46, s46, 1
    s_cmp_eq_u32 s46, 0
    s_waitcnt vmcnt(9) lgkmcnt(0)
    s_cbranch_scc0 K2_hloop
K2_hrest:
    s_waitcnt vmcnt(0)
    s_add_u32 s48, s48, 1024
    s_cmp_ge_u32 s48, s45
    s_cbranch_scc1 K2_end
K2_hrest2:
    s_barrier
    s_sub_u32 s47, s47, 1
    s_cbranch_scc0 K2_hrest2
    s_branch K2_hpass
K2_compute:
    s_lshl_b32 s38, s35, 2
    s_add_u32 s38, s38, s37
    s_mul_i32 s41, s38, 3125
    s_add_u32 s39, s41, 127
    s_lshr_b32 s39, s39, 7
    s_add_u32 s40, s41, 3252
    s_lshr_b32 s40, s40, 7
    s_sub_u32 s40, s40, s39
    v_bfe_u32 v8, v1, 2, 2
    v_bfe_u32 v9, v1, 5, 1
    v_lshl_or_b32 v8, v9, 2, v8
    v_add_lshl_u32 v8, v8, s39, 7
    v_and_b32 v10, 3, v1
    v_lshl_or_b32 v8, v10, 4, v8
    v_bfe_u32 v10, v1, 4, 1
    v_lshl_or_b32 v8, v10, 6, v8
    v_add_u32 v5, s53, v2
    s_mov_b32 s88, s76
    s_mov_b32 s89, s77
    s_mov_b32 s90, 18432
    s_mov_b32 s91, 0x20000
    s_add_u32 s60, s32, 4352
    s_lshl_b32 s41, s37, 11
    s_mov_b32 m0, s41
    s_mov_b32 s12, s4
    s_mov_b32 s13, s5
    s_mov_b32 s14, 3200000
    s_mov_b32 s15, 0x20000
    buffer_load_dwordx4 v2, s[88:91], s41 offen offset:0 lds
    buffer_load_dwordx4 v2, s[88:91], s41 offen offset:1024 lds
    s_lshl_b32 s41, s39, 7
    s_lshl_b32 s42, s40, 7
    s_add_u32 s20, s80, s41
    s_addc_u32 s21, s81, 0
    s_mov_b32 s22, s42
    s_mov_b32 s23, 0x20000
    s_mov_b32 s54, 1.0
    s_mov_b32 s55, 1.0
    v_mul_u32_u24 v13, 26, v1
    v_lshrrev_b32 v13, 8, v13
    s_mul_i32 s41, s37, 288
    s_add_u32 s41, s41, 57664
    v_lshl_add_u32 v16, v13, 2, s41
    v_mul_u32_u24 v14, 10, v13
    v_sub_u32 v14, v1, v14
    v_lshlrev_b32 v17, 18, v14
    v_or_b32 v17, 0xffff, v17
    v_cmp_lt_u32 vcc, 59, v1
    s_nop 1
    v_cndmask_b32 v17, v17, -1, vcc
    v_mul_u32_u24 v14, 12640, v13
    v_add_u32 v18, v14, v2
    v_bfe_u32 v14, v1, 4, 1
    v_bfe_u32 v15, v1, 3, 1
    v_lshl_or_b32 v14, v14, 1, v15
    v_mul_u32_u24 v7, 1040, v14
    v_bfe_u32 v14, v1, 2, 1
    v_lshl_add_u32 v7, v14, 9, v7
    v_bfe_u32 v14, v1, 5, 1
    v_lshl_add_u32 v7, v14, 8, v7
    v_and_b32 v14, 3, v1
    v_lshl_add_u32 v7, v14, 6, v7
    v_bfe_u32 v14, v1, 4, 1
    v_bfe_u32 v15, v1, 2, 1
    v_lshl_or_b32 v14, v14, 1, v15
    v_mul_u32_u24 v19, 1040, v14
    v_bfe_u32 v14, v1, 3, 1
    v_lshl_add_u32 v19, v14, 9, v19
    v_bfe_u32 v14, v1, 5, 1
    v_lshl_add_u32 v19, v14, 8, v19
    v_and_b32 v14, 3, v1
    v_lshl_add_u32 v19, v14, 6, v19
    v_add_u32 v3, s60, v7
    v_add_u32 v19, s60, v19
    v_bfe_u32 v14, v1, 2, 2
    v_lshlrev_b32 v20, 7, v14
    v_bfe_u32 v14, v1, 4, 1
    v_lshl_or_b32 v20, v14, 5, v20
    v_and_b32 v14, 3, v1
    v_lshl_or_b32 v20, v14, 3, v20
    v_lshl_or_b32 v21, v9, 10, v20
    v_lshl_or_b32 v20, v9, 12, v20
    v_bfe_u32 v14, v1, 2, 2
    v_lshlrev_b32 v22, 7, v14
    v_and_b32 v14, 1, v1
    v_lshl_or_b32 v22, v14, 6, v22
    v_and_or_b32 v22, v1, 16, v22
    v_bfe_u32 v14, v1, 1, 1
    v_lshl_or_b32 v22, v14, 3, v22
    v_add_u32 v22, 61312, v22
    v_lshl_add_u32 v23, v9, 9, v22
    v_lshl_add_u32 v22, v9, 12, v22
    v_bfe_u32 v14, v1, 2, 1
    v_cmp_eq_u32 vcc, v14, v9
    v_and_b32 v14, 1, v1
    v_lshlrev_b32 v14, 4, v14
    v_mov_b32 v15, 0x3f80
    v_lshlrev_b32 v15, v14, v15
    v_cndmask_b32 v15, 0, v15, vcc
    v_bfe_u32 v14, v1, 3, 2
    v_bfe_u32 v10, v1, 1, 1
    v_lshl_or_b32 v14, v14, 1, v10
    v_cmp_eq_u32 vcc, 0, v14
    s_nop 1
    v_cndmask_b32 v220, 0, v15, vcc
    v_cmp_eq_u32 vcc, 1, v14
    s_nop 1
    v_cndmask_b32 v221, 0, v15, vcc
    v_cmp_eq_u32 vcc, 2, v14
    s_nop 1
    v_cndmask_b32 v222, 0, v15, vcc
    v_cmp_eq_u32 vcc, 3, v14
    s_nop 1
    v_cndmask_b32 v223, 0, v15, vcc
    v_cmp_eq_u32 vcc, 4, v14
    s_nop 1
    v_cndmask_b32 v224, 0, v15, vcc
    v_cmp_eq_u32 vcc, 5, v14
    s_nop 1
    v_cndmask_b32 v225, 0, v15, vcc
    v_cmp_eq_u32 vcc, 6, v14
    s_nop 1
    v_cndmask_b32 v226, 0, v15, vcc
    v_cmp_eq_u32 vcc, 7, v14
    s_nop 1
    v_cndmask_b32 v227, 0, v15, vcc
    s_mov_b32 s56, 0xbfb8aa3b
    s_mov_b32 s57, 0xbfb8aa3b
    s_cmp_lt_u32 s36, 0
    s_cselect_b32 s3, 0x10001, 1
    v_mov_b32 v206, s3
    v_mov_b32 v207, 127
    v_cmp_gt_u32 s[24:25], s33, v204
    v_lshrrev_b32 v209, 1, v204
    v_add_u32 v209, 2048, v209
    v_cmp_gt_u32 s[26:27], s33, v209
    v_add_u32 v210, 3072, v1
    s_cmp_eq_u32 s36, 7
    s_cselect_b32 s41, s33, 0
    v_cmp_gt_u32 s[28:29], s41, v210
    s_mov_b32 s30, 10995117
    s_mov_b32 s31, 3125
    v_mov_b32 v211, 1
    s_waitcnt vmcnt(4)
    s_mov_b64 exec, s[24:25]
    v_lshlrev_b32 v184, 4, v168
    v_mul_hi_u32_u24 v212, s30, v184
    v_lshlrev_b32 v184, 2, v212
    ds_add_rtn_u32 v192, v184, v206 offset:36928
    v_lshlrev_b32 v185, 4, v169
    v_mul_hi_u32_u24 v213, s30, v185
    v_lshlrev_b32 v185, 2, v213
    ds_add_rtn_u32 v193, v185, v206 offset:36928
    v_lshlrev_b32 v186, 4, v170
    v_mul_hi_u32_u24 v214, s30, v186
    v_lshlrev_b32 v186, 2, v214
    ds_add_rtn_u32 v194, v186, v206 offset:36928
    v_lshlrev_b32 v187, 4, v171
    v_mul_hi_u32_u24 v215, s30, v187
    v_lshlrev_b32 v187, 2, v215
    ds_add_rtn_u32 v195, v187, v206 offset:36928
    s_mov_b64 exec, s[26:27]
    v_lshlrev_b32 v188, 4, v172
    v_mul_hi_u32_u24 v216, s30, v188
    v_lshlrev_b32 v188, 2, v216
    ds_add_rtn_u32 v196, v188, v211 offset:36928
    v_lshlrev_b32 v189, 4, v173
    v_mul_hi_u32_u24 v217, s30, v189
    v_lshlrev_b32 v189, 2, v217
    ds_add_rtn_u32 v197, v189, v211 offset:36928
    s_mov_b64 exec, -1
    s_mul_i32 s41, s37, 3072
    s_add_u32 s41, s41, 8192
    s_mov_b32 m0, s41
    s_nop 0
    buffer_load_dwordx4 v2, s[88:91], s41 offen offset:0 lds
    buffer_load_dwordx4 v2, s[88:91], s41 offen offset:1024 lds
    buffer_load_dwordx4 v2, s[88:91], s41 offen offset:2048 lds
    s_add_u32 m0, s60, 0
    s_nop 0
    buffer_load_dwordx4 v8, s[12:15], 0 offen offset:0 lds
    s_add_u32 m0, s60, 16
    s_nop 0
    buffer_load_dwordx4 v8, s[12:15], 0 offen offset:1024 lds
    s_add_u32 m0, s60, 32
    s_nop 0
    buffer_load_dwordx4 v8, s[12:15], 0 offen offset:2048 lds
    s_add_u32 m0, s60, 48
    s_nop 0
    buffer_load_dwordx4 v8, s[12:15], 0 offen offset:3072 lds
    s_waitcnt vmcnt(7)
    s_waitcnt lgkmcnt(0)
    s_barrier
    ds_read_b64_tr_b16 v[40:41], v20 offset:0
    ds_read_b64_tr_b16 v[42:43], v20 offset:512
    ds_read_b64_tr_b16 v[44:45], v20 offset:1024
    ds_read_b64_tr_b16 v[46:47], v20 offset:1536
    ds_read_b64_tr_b16 v[48:49], v20 offset:2048
    ds_read_b64_tr_b16 v[50:51], v20 offset:2560
    ds_read_b64_tr_b16 v[52:53], v20 offset:3072
    ds_read_b64_tr_b16 v[54:55], v20 offset:3584
    ds_read_b64_tr_b16 v[56:57], v20 offset:64
    ds_read_b64_tr_b16 v[58:59], v20 offset:576
    ds_read_b64_tr_b16 v[60:61], v20 offset:1088
    ds_read_b64_tr_b16 v[62:63], v20 offset:1600
    s_mov_b32 s88, s78
    s_mov_b32 s89, s79
    s_mov_b32 s90, 16384
    s_mov_b32 s91, 0x20000
    s_lshl_b32 s41, s37, 12
    s_add_u32 m0, s41, 61312
    s_nop 0
    buffer_load_dwordx4 v2, s[88:91], s41 offen offset:0 lds
    buffer_load_dwordx4 v2, s[88:91], s41 offen offset:1024 lds
    buffer_load_dwordx4 v2, s[88:91], s41 offen offset:2048 lds
    buffer_load_dwordx4 v2, s[88:91], s41 offen offset:3072 lds
    s_add_u32 s84, s10, 5242880
    s_addc_u32 s85, s11, 0
    s_mov_b32 s86, 24576
    s_mov_b32 s87, 0x20000
    s_lshl_b32 s41, s39, 7
    s_add_u32 s41, s41, 8388608
    s_lshl_b32 s42, s40, 7
    s_add_u32 s16, s10, s41
    s_addc_u32 s17, s11, 0
    s_mov_b32 s18, s42
    s_mov_b32 s19, 0x20000
    s_waitcnt lgkmcnt(8)
    ds_read_b64_tr_b16 v[64:65], v20 offset:2112
    ds_read_b64_tr_b16 v[66:67], v20 offset:2624
    ds_read_b64_tr_b16 v[68:69], v20 offset:3136
    ds_read_b64_tr_b16 v[70:71], v20 offset:3648
    v_mad_u32_u24 v212, v212, s31, v207
    v_lshrrev_b32 v212, 7, v212
    v_sub_u32 v212, v168, v212
    v_lshl_or_b32 v176, v212, 15, v176
    v_add_u32 v212, 0, v204
    v_lshl_or_b32 v176, v212, 20, v176
    v_mad_u32_u24 v213, v213, s31, v207
    v_lshrrev_b32 v213, 7, v213
    v_sub_u32 v213, v169, v213
    v_lshl_or_b32 v177, v213, 15, v177
    v_add_u32 v213, 1, v204
    v_lshl_or_b32 v177, v213, 20, v177
    v_mad_u32_u24 v214, v214, s31, v207
    v_lshrrev_b32 v214, 7, v214
    v_sub_u32 v214, v170, v214
    v_lshl_or_b32 v178, v214, 15, v178
    v_add_u32 v214, 2, v204
    v_lshl_or_b32 v178, v214, 20, v178
    v_mad_u32_u24 v215, v215, s31, v207
    v_lshrrev_b32 v215, 7, v215
    v_sub_u32 v215, v171, v215
    v_lshl_or_b32 v179, v215, 15, v179
    v_add_u32 v215, 3, v204
    v_lshl_or_b32 v179, v215, 20, v179
    v_mad_u32_u24 v216, v216, s31, v207
    v_lshrrev_b32 v216, 7, v216
    v_sub_u32 v216, v172, v216
    v_lshl_or_b32 v180, v216, 15, v180
    v_add_u32 v216, 0, v209
    v_lshl_or_b32 v180, v216, 20, v180
    v_mad_u32_u24 v217, v217, s31, v207
    v_lshrrev_b32 v217, 7, v217
    v_sub_u32 v217, v173, v217
    v_lshl_or_b32 v181, v217, 15, v181
    v_add_u32 v217, 1, v209
    v_lshl_or_b32 v181, v217, 20, v181
    s_waitcnt lgkmcnt(0)
    s_barrier
    s_mov_b64 exec, s[24:25]
    ds_read_b32 v184, v184 offset:53568
    ds_read_b32 v185, v185 offset:53568
    ds_read_b32 v186, v186 offset:53568
    ds_read_b32 v187, v187 offset:53568
    s_mov_b64 exec, s[26:27]
    ds_read_b32 v188, v188 offset:53568
    ds_read_b32 v189, v189 offset:53568
    s_mov_b64 exec, -1
    s_lshl_b32 s62, s2, 5
    s_add_u32 s62, s62, 8192
    v_and_b32 v10, 31, v1
    v_mul_u32_u24 v10, 144, v10
    v_lshl_add_u32 v10, v9, 6, v10
    v_add_u32 v10, s60, v10
    v_lshrrev_b32 v11, 3, v1
    v_add_lshl_u32 v11, v11, v1, 4
    v_add_u32 v11, s60, v11
    v_mov_b32 v12, 0
    s_add_u32 s88, s10, 4194304
    s_addc_u32 s89, s11, 0
    s_mov_b32 s90, 1048576
    s_mov_b32 s91, 0x20000
    s_lshl_b32 s76, s37, 12
    s_lshl_b32 s42, s35, 4
    s_add_u32 s76, s76, s42
    v_lshlrev_b32 v8, 14, v1
    s_waitcnt lgkmcnt(0)
    s_mov_b64 exec, s[24:25]
    v_add_lshl_u32 v184, v184, v192, 2
    ds_write_b32 v184, v176 offset:41024
    v_add_lshl_u32 v185, v185, v193, 2
    ds_write_b32 v185, v177 offset:41024
    v_add_lshl_u32 v186, v186, v194, 2
    ds_write_b32 v186, v178 offset:41024
    v_add_lshl_u32 v187, v187, v195, 2
    ds_write_b32 v187, v179 offset:41024
    s_mov_b64 exec, s[26:27]
    v_add_lshl_u32 v188, v188, v196, 2
    ds_write_b32 v188, v180 offset:41024
    v_add_lshl_u32 v189, v189, v197, 2
    ds_write_b32 v189, v181 offset:41024
    s_mov_b64 exec, -1
    s_waitcnt vmcnt(8)
    s_waitcnt lgkmcnt(0)
    s_barrier
    s_waitcnt vmcnt(4)
    ds_read_b128 v[24:27], v3 offset:0
    ds_read_b128 v[28:31], v3 offset:16
    ds_read_b128 v[32:35], v3 offset:32
    ds_read_b128 v[36:39], v3 offset:48
    ds_read_b128 v[236:239], v19 offset:0
    ds_read_b128 v[240:243], v19 offset:16
    ds_read_b128 v[244:247], v19 offset:32
    ds_read_b128 v[248:251], v19 offset:48
    s_waitcnt lgkmcnt(4)
    v_mfma_f32_32x32x16_bf16 v[136:151], v[40:43], v[24:27], 0
    v_mfma_f32_32x32x16_bf16 v[136:151], v[44:47], v[28:31], v[136:151]
    v_mfma_f32_32x32x16_bf16 v[136:151], v[48:51], v[32:35], v[136:151]
    v_mfma_f32_32x32x16_bf16 v[136:151], v[52:55], v[36:39], v[136:151]
    s_nop 2
    ds_read_b32 v13, v12 offset:32800
    s_nop 7
    v_mfma_f32_32x32x16_bf16 v[152:167], v[56:59], v[24:27], 0
    v_mul_f32 v136, s56, v136
    v_mul_f32 v137, s56, v137
    v_mul_f32 v138, s56, v138
    v_mul_f32 v139, s56, v139
    v_mfma_f32_32x32x16_bf16 v[152:167], v[60:63], v[28:31], v[152:167]
    v_mul_f32 v140, s56, v140
    v_mul_f32 v141, s56, v141
    v_mul_f32 v142, s56, v142
    v_mul_f32 v143, s56, v143
    v_mfma_f32_32x32x16_bf16 v[152:167], v[64:67], v[32:35], v[152:167]
    v_mul_f32 v144, s56, v144
    v_mul_f32 v145, s56, v145
    v_mul_f32 v146, s56, v146
    v_mul_f32 v147, s56, v147
    v_mfma_f32_32x32x16_bf16 v[152:167], v[68:71], v[36:39], v[152:167]
    v_mul_f32 v148, s56, v148
    v_mul_f32 v149, s56, v149
    v_mul_f32 v150, s56, v150
    v_mul_f32 v151, s56, v151
    v_cvt_pk_bf16_f32 v168, v136, v137
    v_cvt_pk_bf16_f32 v169, v138, v139
    v_cvt_pk_bf16_f32 v170, v140, v141
    v_cvt_pk_bf16_f32 v171, v142, v143
    v_cvt_pk_bf16_f32 v172, v144, v145
    v_cvt_pk_bf16_f32 v173, v146, v147
    v_cvt_pk_bf16_f32 v174, v148, v149
    v_cvt_pk_bf16_f32 v175, v150, v151
    ds_write_b128 v10, v[168:171] offset:0
    ds_write_b128 v10, v[172:175] offset:16
    buffer_load_dwordx4 v[212:215], v8, s[88:91], s76 offen sc1
    v_mul_f32 v152, s56, v152
    v_mul_f32 v153, s56, v153
    v_mul_f32 v154, s56, v154
    v_mul_f32 v155, s56, v155
    v_mul_f32 v156, s56, v156
    v_mul_f32 v157, s56, v157
    v_mul_f32 v158, s56, v158
    v_mul_f32 v159, s56, v159
    v_mul_f32 v160, s56, v160
    v_mul_f32 v161, s56, v161
    v_mul_f32 v162, s56, v162
    v_mul_f32 v163, s56, v163
    v_mul_f32 v164, s56, v164
    v_mul_f32 v165, s56, v165
    v_mul_f32 v166, s56, v166
    v_mul_f32 v167, s56, v167
    v_cvt_pk_bf16_f32 v176, v152, v153
    v_cvt_pk_bf16_f32 v177, v154, v155
    v_cvt_pk_bf16_f32 v178, v156, v157
    v_cvt_pk_bf16_f32 v179, v158, v159
    v_cvt_pk_bf16_f32 v180, v160, v161
    v_cvt_pk_bf16_f32 v181, v162, v163
    v_cvt_pk_bf16_f32 v182, v164, v165
    v_cvt_pk_bf16_f32 v183, v166, v167
    ds_write_b128 v10, v[176:179] offset:32
    ds_write_b128 v10, v[180:183] offset:48
    ds_read_b128 v[184:187], v11 offset:0
    ds_read_b128 v[188:191], v11 offset:1152
    ds_read_b128 v[192:195], v11 offset:2304
    ds_read_b128 v[196:199], v11 offset:3456
    s_waitcnt lgkmcnt(4)
    v_readfirstlane_b32 s63, v13
    ds_read_b64_tr_b16 v[104:105], v20 offset:8192
    ds_read_b64_tr_b16 v[106:107], v20 offset:8704
    ds_read_b64_tr_b16 v[108:109], v20 offset:9216
    ds_read_b64_tr_b16 v[110:111], v20 offset:9728
    ds_read_b64_tr_b16 v[112:113], v20 offset:10240
    ds_read_b64_tr_b16 v[114:115], v20 offset:10752
    ds_read_b64_tr_b16 v[116:117], v20 offset:11264
    ds_read_b64_tr_b16 v[118:119], v20 offset:11776
    ds_read_b64_tr_b16 v[120:121], v20 offset:8256
    ds_read_b64_tr_b16 v[122:123], v20 offset:8768
    s_waitcnt lgkmcnt(5)
    ds_read_b64_tr_b16 v[124:125], v20 offset:9280
    ds_read_b64_tr_b16 v[126:127], v20 offset:9792
    ds_read_b64_tr_b16 v[128:129], v20 offset:10304
    ds_read_b64_tr_b16 v[130:131], v20 offset:10816
    ds_read_b64_tr_b16 v[132:133], v20 offset:11328
    ds_read_b64_tr_b16 v[134:135], v20 offset:11840
    ds_read_b64_tr_b16 v[228:229], v21 offset:16384
    ds_read_b64_tr_b16 v[230:231], v21 offset:16896
    ds_read_b64_tr_b16 v[232:233], v21 offset:16448
    ds_read_b64_tr_b16 v[234:235], v21 offset:16960
    buffer_store_dwordx4 v[184:187], v2, s[16:19], 0 offen offset:0 sc1
    buffer_store_dwordx4 v[188:191], v2, s[16:19], 0 offen offset:1024 sc1
    buffer_store_dwordx4 v[192:195], v2, s[16:19], 0 offen offset:2048 sc1
    buffer_store_dwordx4 v[196:199], v2, s[16:19], 0 offen offset:3072 sc1
    s_mov_b32 s24, s10
    s_or_b32 s25, s11, 262144
    s_mov_b32 s26, 3136
    s_mov_b32 s27, 0x20000
    s_mul_i32 s58, s37, 921600
    s_mul_i32 s59, s37, 11520
    s_add_u32 s59, s59, 78400
    s_mul_i32 s41, s37, 2304
    v_and_b32 v11, 7, v1
    s_cmp_eq_u32 s37, 3
    s_cselect_b32 s70, 39, 63
    s_cselect_b32 s71, 0, 64
    v_min_u32 v10, s70, v1
    v_lshlrev_b32 v10, 5, v10
    v_add_lshl_u32 v11, v11, s71, 5
    s_mov_b32 s74, 0xf000f000
    s_mov_b32 s75, 262144
    s_lshl_b32 s70, s63, 0
    s_and_b32 s70, s70, s74
    s_lshl_b32 s71, s63, 4
    s_and_b32 s71, s71, s74
    s_lshl_b32 s72, s63, 8
    s_and_b32 s72, s72, s74
    s_lshl_b32 s73, s63, 12
    s_and_b32 s73, s73, s74
    v_mov_b32 v169, v18
    v_mov_b32 v171, v18
    v_mov_b32 v173, v18
    v_mov_b32 v175, v18
    v_mov_b32 v177, v18
    v_mov_b32 v179, v18
    v_mov_b32 v181, v18
    v_mov_b32 v183, v18
    v_mov_b32 v185, v18
    v_mov_b32 v187, v18
    v_mov_b32 v189, v18
    v_mov_b32 v191, v18
    s_waitcnt vmcnt(4) lgkmcnt(0)
    s_branch KS_poll1
KS_poll:
    buffer_load_dwordx4 v[212:215], v8, s[88:91], s76 offen sc1
    s_waitcnt vmcnt(0)
KS_poll1:
    v_xor_b32 v212, s70, v212
    v_xor_b32 v213, s71, v213
    v_xor_b32 v214, s72, v214
    v_xor_b32 v215, s73, v215
    v_or3_b32 v14, v212, v213, v214
    v_or_b32 v14, v14, v215
    v_and_b32 v14, s74, v14
    v_cmp_ne_u32 vcc, 0, v14
    s_sub_u32 s75, s75, 1
    s_cbranch_scc1 KS_poll_done
    s_and_b64 exec, exec, vcc
    s_cbranch_scc1 KS_poll
KS_poll_done:
    s_mov_b64 exec, -1
    s_lshl_b32 s42, s37, 10
    v_add_u32 v14, s42, v2
    ds_write_b128 v14, v[212:215] offset:32832
    v_add_u32_sdwa v15, v215, v215 dst_sel:DWORD dst_unused:UNUSED_PAD src0_sel:WORD_0 src1_sel:WORD_1
    v_and_b32 v8, 0xffff, v212
    v_sub_u32 v15, v15, v8
    v_lshl_or_b32 v15, v15, 16, v8
    s_lshl_b32 s42, s37, 2
    v_add_u32 v8, s42, v2
    ds_write_b32 v8, v15 offset:57664
    s_waitcnt lgkmcnt(0)
    s_barrier
    ds_read_b32 v168, v16 offset:0
    ds_read_b32 v170, v16 offset:24
    ds_read_b32 v172, v16 offset:48
    ds_read_b32 v174, v16 offset:72
    ds_read_b32 v176, v16 offset:96
    ds_read_b32 v178, v16 offset:120
    ds_read_b32 v180, v16 offset:144
    ds_read_b32 v182, v16 offset:168
    ds_read_b32 v184, v16 offset:192
    ds_read_b32 v186, v16 offset:216
    ds_read_b32 v188, v16 offset:240
    ds_read_b32 v190, v16 offset:264
    v_mfma_f32_32x32x16_bf16 v[136:151], v[236:239], v[104:107], 0
    v_mfma_f32_32x32x16_bf16 v[136:151], v[240:243], v[108:111], v[136:151]
    v_mfma_f32_32x32x16_bf16 v[136:151], v[244:247], v[112:115], v[136:151]
    v_mfma_f32_32x32x16_bf16 v[136:151], v[248:251], v[116:119], v[136:151]
    v_mfma_f32_32x32x16_bf16 v[152:167], v[236:239], v[120:123], 0
    v_mfma_f32_32x32x16_bf16 v[152:167], v[240:243], v[124:127], v[152:167]
    v_mfma_f32_32x32x16_bf16 v[152:167], v[244:247], v[128:131], v[152:167]
    v_mfma_f32_32x32x16_bf16 v[152:167], v[248:251], v[132:135], v[152:167]
    s_waitcnt vmcnt(0)
    s_mov_b64 exec, 1
    v_mov_b32 v14, 1
    ds_add_rtn_u32 v14, v12, v14 offset:32812
    s_waitcnt lgkmcnt(0)
    v_cmp_eq_u32 vcc, 3, v14
    s_and_b64 exec, exec, vcc
    s_cbranch_execz KS_sig1
    buffer_store_dword v13, v12, s[84:87], s62 offen sc1
KS_sig1:
    s_mov_b64 exec, -1
    v_lshlrev_b32 v14, 16, v228
    v_and_b32 v15, 0xffff0000, v228
    v_mul_f32 v14, s56, v14
    v_mul_f32 v15, s56, v15
    v_cvt_pk_bf16_f32 v228, v14, v15
    v_lshlrev_b32 v14, 16, v229
    v_and_b32 v15, 0xffff0000, v229
    v_mul_f32 v14, s56, v14
    v_mul_f32 v15, s56, v15
    v_cvt_pk_bf16_f32 v229, v14, v15
    v_lshlrev_b32 v14, 16, v230
    v_and_b32 v15, 0xffff0000, v230
    v_mul_f32 v14, s56, v14
    v_mul_f32 v15, s56, v15
    v_cvt_pk_bf16_f32 v230, v14, v15
    v_lshlrev_b32 v14, 16, v231
    v_and_b32 v15, 0xffff0000, v231
    v_mul_f32 v14, s56, v14
    v_mul_f32 v15, s56, v15
    v_cvt_pk_bf16_f32 v231, v14, v15
    v_lshlrev_b32 v14, 16, v232
    v_and_b32 v15, 0xffff0000, v232
    v_mul_f32 v14, s56, v14
    v_mul_f32 v15, s56, v15
    v_cvt_pk_bf16_f32 v232, v14, v15
    v_lshlrev_b32 v14, 16, v233
    v_and_b32 v15, 0xffff0000, v233
    v_mul_f32 v14, s56, v14
    v_mul_f32 v15, s56, v15
    v_cvt_pk_bf16_f32 v233, v14, v15
    v_lshlrev_b32 v14, 16, v234
    v_and_b32 v15, 0xffff0000, v234
    v_mul_f32 v14, s56, v14
    v_mul_f32 v15, s56, v15
    v_cvt_pk_bf16_f32 v234, v14, v15
    v_lshlrev_b32 v14, 16, v235
    v_and_b32 v15, 0xffff0000, v235
    v_mul_f32 v14, s56, v14
    v_mul_f32 v15, s56, v15
    v_cvt_pk_bf16_f32 v235, v14, v15
    buffer_load_dword v204, v10, s[84:87], s41 offen sc1
    buffer_load_dword v205, v11, s[84:87], s41 offen sc1
    v_pk_mul_f32 v[136:137], v[136:137], s[56:57]
    v_pk_mul_f32 v[138:139], v[138:139], s[56:57]
    v_pk_mul_f32 v[140:141], v[140:141], s[56:57]
    v_pk_mul_f32 v[142:143], v[142:143], s[56:57]
    v_pk_mul_f32 v[144:145], v[144:145], s[56:57]
    v_pk_mul_f32 v[146:147], v[146:147], s[56:57]
    v_pk_mul_f32 v[148:149], v[148:149], s[56:57]
    v_pk_mul_f32 v[150:151], v[150:151], s[56:57]
    v_pk_mul_f32 v[152:153], v[152:153], s[56:57]
    v_pk_mul_f32 v[154:155], v[154:155], s[56:57]
    v_pk_mul_f32 v[156:157], v[156:157], s[56:57]
    v_pk_mul_f32 v[158:159], v[158:159], s[56:57]
    v_pk_mul_f32 v[160:161], v[160:161], s[56:57]
    v_pk_mul_f32 v[162:163], v[162:163], s[56:57]
    v_pk_mul_f32 v[164:165], v[164:165], s[56:57]
    v_pk_mul_f32 v[166:167], v[166:167], s[56:57]
    v_cvt_pk_bf16_f32 v236, v136, v137
    v_cvt_pk_bf16_f32 v237, v138, v139
    v_cvt_pk_bf16_f32 v238, v140, v141
    v_cvt_pk_bf16_f32 v239, v142, v143
    v_cvt_pk_bf16_f32 v240, v144, v145
    v_cvt_pk_bf16_f32 v241, v146, v147
    v_cvt_pk_bf16_f32 v242, v148, v149
    v_cvt_pk_bf16_f32 v243, v150, v151
    v_cvt_pk_bf16_f32 v244, v152, v153
    v_cvt_pk_bf16_f32 v245, v154, v155
    v_cvt_pk_bf16_f32 v246, v156, v157
    v_cvt_pk_bf16_f32 v247, v158, v159
    v_cvt_pk_bf16_f32 v248, v160, v161
    v_cvt_pk_bf16_f32 v249, v162, v163
    v_cvt_pk_bf16_f32 v250, v164, v165
    v_cvt_pk_bf16_f32 v251, v166, v167
    s_branch KS_fpoll_w
KS_fpoll:
    buffer_load_dword v204, v10, s[84:87], s41 offen sc1
    buffer_load_dword v205, v11, s[84:87], s41 offen sc1
KS_fpoll_w:
    s_waitcnt vmcnt(0)
KS_fpoll_c:
    v_cmp_ne_u32 vcc, s63, v204
    v_cmp_ne_u32 s[70:71], s63, v205
    s_sub_u32 s75, s75, 1
    s_cbranch_scc1 KS_fpoll_done
    s_or_b64 vcc, vcc, s[70:71]
    s_and_b64 exec, exec, vcc
    s_cbranch_scc1 KS_fpoll
KS_fpoll_done:
    s_mov_b64 exec, -1
    s_waitcnt lgkmcnt(11)
    v_cmp_lt_u32 vcc, v17, v168
    v_and_b32 v168, 0xffff, v168
    s_add_u32 m0, s59, 0
    s_mov_b64 exec, vcc
    buffer_load_dwordx4 v[168:169], s[24:27], s58 idxen offen sc1 lds
    s_mov_b64 exec, -1
    s_add_u32 s58, s58, 76800
    s_waitcnt lgkmcnt(10)
    v_cmp_lt_u32 vcc, v17, v170
    v_and_b32 v170, 0xffff, v170
    s_add_u32 m0, s59, 960
    s_mov_b64 exec, vcc
    buffer_load_dwordx4 v[170:171], s[24:27], s58 idxen offen sc1 lds
    s_mov_b64 exec, -1
    s_add_u32 s58, s58, 76800
    s_waitcnt lgkmcnt(9)
    v_cmp_lt_u32 vcc, v17, v172
    v_and_b32 v172, 0xffff, v172
    s_add_u32 m0, s59, 1920
    s_mov_b64 exec, vcc
    buffer_load_dwordx4 v[172:173], s[24:27], s58 idxen offen sc1 lds
    s_mov_b64 exec, -1
    s_add_u32 s58, s58, 76800
    s_waitcnt lgkmcnt(8)
    v_cmp_lt_u32 vcc, v17, v174
    v_and_b32 v174, 0xffff, v174
    s_add_u32 m0, s59, 2880
    s_mov_b64 exec, vcc
    buffer_load_dwordx4 v[174:175], s[24:27], s58 idxen offen sc1 lds
    s_mov_b64 exec, -1
    s_add_u32 s58, s58, 76800
    s_waitcnt lgkmcnt(7)
    v_cmp_lt_u32 vcc, v17, v176
    v_and_b32 v176, 0xffff, v176
    s_add_u32 m0, s59, 3840
    s_mov_b64 exec, vcc
    buffer_load_dwordx4 v[176:177], s[24:27], s58 idxen offen sc1 lds
    s_mov_b64 exec, -1
    s_add_u32 s58, s58, 76800
    s_waitcnt lgkmcnt(6)
    v_cmp_lt_u32 vcc, v17, v178
    v_and_b32 v178, 0xffff, v178
    s_add_u32 m0, s59, 4800
    s_mov_b64 exec, vcc
    buffer_load_dwordx4 v[178:179], s[24:27], s58 idxen offen sc1 lds
    s_mov_b64 exec, -1
    s_add_u32 s58, s58, 76800
    s_waitcnt lgkmcnt(5)
    v_cmp_lt_u32 vcc, v17, v180
    v_and_b32 v180, 0xffff, v180
    s_add_u32 m0, s59, 5760
    s_mov_b64 exec, vcc
    buffer_load_dwordx4 v[180:181], s[24:27], s58 idxen offen sc1 lds
    s_mov_b64 exec, -1
    s_add_u32 s58, s58, 76800
    s_cmp_eq_u32 s37, 3
    s_cbranch_scc1 K2_win_done
    s_waitcnt lgkmcnt(4)
    v_cmp_lt_u32 vcc, v17, v182
    v_and_b32 v182, 0xffff, v182
    s_add_u32 m0, s59, 6720
    s_mov_b64 exec, vcc
    buffer_load_dwordx4 v[182:183], s[24:27], s58 idxen offen sc1 lds
    s_mov_b64 exec, -1
    s_add_u32 s58, s58, 76800
    s_waitcnt lgkmcnt(3)
    v_cmp_lt_u32 vcc, v17, v184
    v_and_b32 v184, 0xffff, v184
    s_add_u32 m0, s59, 7680
    s_mov_b64 exec, vcc
    buffer_load_dwordx4 v[184:185], s[24:27], s58 idxen offen sc1 lds
    s_mov_b64 exec, -1
    s_add_u32 s58, s58, 76800
    s_waitcnt lgkmcnt(2)
    v_cmp_lt_u32 vcc, v17, v186
    v_and_b32 v186, 0xffff, v186
    s_add_u32 m0, s59, 8640
    s_mov_b64 exec, vcc
    buffer_load_dwordx4 v[186:187], s[24:27], s58 idxen offen sc1 lds
    s_mov_b64 exec, -1
    s_add_u32 s58, s58, 76800
    s_waitcnt lgkmcnt(1)
    v_cmp_lt_u32 vcc, v17, v188
    v_and_b32 v188, 0xffff, v188
    s_add_u32 m0, s59, 9600
    s_mov_b64 exec, vcc
    buffer_load_dwordx4 v[188:189], s[24:27], s58 idxen offen sc1 lds
    s_mov_b64 exec, -1
    s_add_u32 s58, s58, 76800
    s_waitcnt lgkmcnt(0)
    v_cmp_lt_u32 vcc, v17, v190
    v_and_b32 v190, 0xffff, v190
    s_add_u32 m0, s59, 10560
    s_mov_b64 exec, vcc
    buffer_load_dwordx4 v[190:191], s[24:27], s58 idxen offen sc1 lds
    s_mov_b64 exec, -1
K2_win_done:
    s_add_u32 s41, s41, 8192
    buffer_load_dword v204, v10, s[84:87], s41 offen sc1
    buffer_load_dword v205, v11, s[84:87], s41 offen sc1
    s_waitcnt lgkmcnt(0)
    ds_read_b64_tr_b16 v[40:41], v22 offset:0
    ds_read_b64_tr_b16 v[42:43], v22 offset:512
    ds_read_b64_tr_b16 v[44:45], v22 offset:1024
    ds_read_b64_tr_b16 v[46:47], v22 offset:1536
    ds_read_b64_tr_b16 v[48:49], v22 offset:2048
    ds_read_b64_tr_b16 v[50:51], v22 offset:2560
    ds_read_b64_tr_b16 v[52:53], v22 offset:3072
    ds_read_b64_tr_b16 v[54:55], v22 offset:3584
    ds_read_b64_tr_b16 v[56:57], v23 offset:8192
    ds_read_b64_tr_b16 v[58:59], v23 offset:9216
    ds_read_b64_tr_b16 v[60:61], v23 offset:10240
    ds_read_b64_tr_b16 v[62:63], v23 offset:11264
    s_waitcnt lgkmcnt(3)
    ds_read_b64_tr_b16 v[64:65], v23 offset:12288
    ds_read_b64_tr_b16 v[66:67], v23 offset:13312
    ds_read_b64_tr_b16 v[68:69], v23 offset:14336
    ds_read_b64_tr_b16 v[70:71], v23 offset:15360
    ds_read_b64_tr_b16 v[72:73], v22 offset:32
    ds_read_b64_tr_b16 v[74:75], v22 offset:544
    ds_read_b64_tr_b16 v[76:77], v22 offset:1056
    ds_read_b64_tr_b16 v[78:79], v22 offset:1568
    ds_read_b64_tr_b16 v[80:81], v22 offset:2080
    ds_read_b64_tr_b16 v[82:83], v22 offset:2592
    ds_read_b64_tr_b16 v[84:85], v22 offset:3104
    ds_read_b64_tr_b16 v[86:87], v22 offset:3616
    s_waitcnt lgkmcnt(3)
    ds_read_b64_tr_b16 v[88:89], v23 offset:8224
    ds_read_b64_tr_b16 v[90:91], v23 offset:9248
    ds_read_b64_tr_b16 v[92:93], v23 offset:10272
    ds_read_b64_tr_b16 v[94:95], v23 offset:11296
    ds_read_b64_tr_b16 v[96:97], v23 offset:12320
    ds_read_b64_tr_b16 v[98:99], v23 offset:13344
    ds_read_b64_tr_b16 v[100:101], v23 offset:14368
    ds_read_b64_tr_b16 v[102:103], v23 offset:15392
    s_waitcnt lgkmcnt(4)
    v_mov_b32 v196, 0
    v_mov_b32 v197, 0
    v_mov_b32 v198, 0
    v_mov_b32 v199, 0
    v_mov_b32 v200, 0
    v_mov_b32 v201, 0
    v_mov_b32 v202, 0
    v_mov_b32 v203, 0
    ds_write_b128 v5, v[196:199] offset:0
    ds_write_b128 v5, v[196:199] offset:1024
    ds_write_b128 v5, v[196:199] offset:2048
    ds_write_b128 v5, v[196:199] offset:3072
    ds_write_b128 v5, v[196:199] offset:4096
    ds_write_b128 v5, v[196:199] offset:5120
    ds_write_b128 v5, v[196:199] offset:6144
    ds_write_b128 v5, v[196:199] offset:7168
    s_branch KS_ppoll_w
KS_ppoll:
    buffer_load_dword v204, v10, s[84:87], s41 offen sc1
    buffer_load_dword v205, v11, s[84:87], s41 offen sc1
KS_ppoll_w:
    s_waitcnt vmcnt(0)
KS_ppoll_c:
    v_cmp_ne_u32 vcc, s63, v204
    v_cmp_ne_u32 s[70:71], s63, v205
    s_sub_u32 s75, s75, 1
    s_cbranch_scc1 KS_ppoll_done
    s_or_b64 vcc, vcc, s[70:71]
    s_and_b64 exec, exec, vcc
    s_cbranch_scc1 KS_ppoll
KS_ppoll_done:
    s_mov_b64 exec, -1
    s_waitcnt lgkmcnt(0)
    s_barrier
    v_mov_b32 v104, 0
    v_mov_b32 v105, 0
    v_mov_b32 v106, 0
    v_mov_b32 v107, 0
    v_mov_b32 v108, 0
    v_mov_b32 v109, 0
    v_mov_b32 v110, 0
    v_mov_b32 v111, 0
    v_mov_b32 v112, 0
    v_mov_b32 v113, 0
    v_mov_b32 v114, 0
    v_mov_b32 v115, 0
    v_mov_b32 v116, 0
    v_mov_b32 v117, 0
    v_mov_b32 v118, 0
    v_mov_b32 v119, 0
    v_mov_b32 v120, 0
    v_mov_b32 v121, 0
    v_mov_b32 v122, 0
    v_mov_b32 v123, 0
    v_mov_b32 v124, 0
    v_mov_b32 v125, 0
    v_mov_b32 v126, 0
    v_mov_b32 v127, 0
    v_mov_b32 v128, 0
    v_mov_b32 v129, 0
    v_mov_b32 v130, 0
    v_mov_b32 v131, 0
    v_mov_b32 v132, 0
    v_mov_b32 v133, 0
    v_mov_b32 v134, 0
    v_mov_b32 v135, 0
K2_cpass:
    s_barrier
K2_cpass1:
    v_add_u32 v3, s43, v7
    v_and_b32 v8, 31, v1
    v_lshlrev_b32 v4, 5, v8
    v_bfe_u32 v9, v1, 5, 1
    v_lshl_add_u32 v4, v9, 4, v4
    v_add_u32 v4, s43, v4
    s_mov_b32 s51, 41472
    v_mov_b32 v16, 0
    v_mov_b32 v17, 0
    v_mov_b32 v18, 0
    v_mov_b32 v19, 0
    v_mov_b32 v20, 0
    v_mov_b32 v21, 0
    v_mov_b32 v22, 0
    v_mov_b32 v23, 0
    v_mov_b32 v212, 0
    v_mov_b32 v213, 0
    v_mov_b32 v214, 0
    v_mov_b32 v215, 0
    s_lshl_b32 s41, s37, 2
    v_mov_b32 v13, s41
    s_waitcnt vmcnt(0) lgkmcnt(0)
    s_barrier
    ds_read_b32 v13, v13 offset:32768
    ds_read_b128 v[168:171], v3 offset:0
    ds_read_b128 v[172:175], v3 offset:16
    ds_read_b128 v[176:179], v3 offset:32
    ds_read_b128 v[180:183], v3 offset:48
    ds_read_b128 v[184:187], v4 offset:4160
    ds_read_b128 v[188:191], v5 offset:0
    ds_read_b128 v[192:195], v5 offset:1024
    v_mov_b32 v12, 0
    ds_read_b128 v[8:11], v12 offset:32768
    s_waitcnt lgkmcnt(0)
    v_max_u32 v12, v8, v9
    v_max3_u32 v12, v12, v10, v11
    s_nop 0
    v_readfirstlane_b32 s45, v12
    v_readfirstlane_b32 s44, v13
    v_mfma_f32_32x32x16_bf16 v[136:151], v[168:171], v[220:223], 0
    s_max_u32 s47, s45, s48
    s_sub_u32 s47, s47, s48
    s_min_u32 s47, s47, 1024
    s_add_u32 s47, s47, 31
    s_lshr_b32 s47, s47, 5
    v_mfma_f32_32x32x16_bf16 v[136:151], v[172:175], v[224:227], v[136:151]
    s_max_u32 s46, s44, s48
    s_sub_u32 s46, s46, s48
    s_min_u32 s46, s46, 1024
    s_add_u32 s46, s46, 31
    s_lshr_b32 s46, s46, 5
    v_mfma_f32_32x32x16_bf16 v[136:151], v[184:187], v[228:231], v[136:151]
    s_sub_u32 s47, s47, s46
    s_add_u32 s48, s48, 1024
    v_mfma_f32_32x32x16_bf16 v[136:151], v[188:191], v[236:239], v[136:151]
    v_mfma_f32_32x32x16_bf16 v[136:151], v[192:195], v[240:243], v[136:151]
    s_cmp_eq_u32 s46, 0
    s_cbranch_scc1 K2_crest
    s_and_b32 s41, s47, -2
    s_cbranch_scc0 K2_cpre_go
    s_sub_u32 s47, s47, s41
K2_cpre:
    s_barrier
    s_sub_u32 s41, s41, 1
    s_cmp_lg_u32 s41, 0
    s_cbranch_scc1 K2_cpre
K2_cpre_go:
    s_barrier
    ds_read_b128 v[168:171], v3 offset:20736
    ds_read_b128 v[172:175], v3 offset:20752
    s_nop 7
    s_cmp_eq_u32 s46, 1
.p2align 6
K2_loop:
    v_mfma_f32_32x32x16_bf16 v[152:167], v[176:179], v[220:223], 0
    ds_read_b128 v[176:179], v3 offset:20768
    v_exp_f32 v8, v136
    v_exp_f32 v9, v137
    v_exp_f32_e64 v10, v138
    v_mfma_f32_32x32x16_bf16 v[152:167], v[180:183], v[224:227], v[152:167]
    ds_read_b128 v[180:183], v3 offset:20784
    v_exp_f32 v11, v139
    v_exp_f32 v12, v140
    v_exp_f32 v13, v141
    v_exp_f32 v14, v142
    v_exp_f32_e64 v15, v143
    v_pk_add_f32 v[8:9], v[8:9], s[54:55]
    v_pk_add_f32 v[10:11], v[10:11], s[54:55]
    v_pk_add_f32 v[12:13], v[12:13], s[54:55]
    v_pk_add_f32 v[14:15], v[14:15], s[54:55]
    v_mfma_f32_32x32x16_bf16 v[152:167], v[184:187], v[232:235], v[152:167]
    ds_read_b128 v[184:187], v4 offset:24896
    v_rcp_f32 v8, v8
    v_rcp_f32 v9, v9
    v_rcp_f32_e64 v10, v10
    v_mfma_f32_32x32x16_bf16 v[152:167], v[188:191], v[244:247], v[152:167]
    ds_read_b128 v[188:191], v5 offset:4096
    v_rcp_f32 v11, v11
    v_rcp_f32 v12, v12
    v_rcp_f32 v13, v13
    v_rcp_f32 v14, v14
    v_rcp_f32_e64 v15, v15
    v_cvt_pk_bf16_f32 v216, v16, v17
    v_cvt_pk_bf16_f32 v217, v18, v19
    v_cvt_pk_bf16_f32 v218, v20, v21
    v_cvt_pk_bf16_f32 v219, v22, v23
    v_pk_mul_f32 v[8:9], v[8:9], v[136:137]
    v_pk_mul_f32 v[10:11], v[10:11], v[138:139]
    v_pk_mul_f32 v[12:13], v[12:13], v[140:141]
    v_pk_mul_f32 v[14:15], v[14:15], v[142:143]
    v_mfma_f32_32x32x16_bf16 v[152:167], v[192:195], v[248:251], v[152:167]
    ds_read_b128 v[192:195], v5 offset:5120
    v_exp_f32 v16, v144
    v_exp_f32 v17, v145
    v_exp_f32_e64 v18, v146
    v_mfma_f32_32x32x16_bf16 v[120:135], v[212:215], v[196:199], v[120:135]
    ds_read_b128 v[196:199], v5 offset:6144
    v_exp_f32 v19, v147
    v_exp_f32 v20, v148
    v_exp_f32 v21, v149
    v_exp_f32 v22, v150
    v_exp_f32_e64 v23, v151
    v_cvt_pk_bf16_f32 v204, v8, v9
    v_cvt_pk_bf16_f32 v205, v10, v11
    v_cvt_pk_bf16_f32 v206, v12, v13
    v_cvt_pk_bf16_f32 v207, v14, v15
    v_pk_add_f32 v[16:17], v[16:17], s[54:55]
    v_pk_add_f32 v[18:19], v[18:19], s[54:55]
    v_pk_add_f32 v[20:21], v[20:21], s[54:55]
    v_pk_add_f32 v[22:23], v[22:23], s[54:55]
    v_mfma_f32_32x32x16_bf16 v[120:135], v[216:219], v[200:203], v[120:135]
    ds_read_b128 v[200:203], v5 offset:7168
    v_rcp_f32 v16, v16
    v_rcp_f32 v17, v17
    v_rcp_f32 v18, v18
    v_rcp_f32 v19, v19
    v_rcp_f32 v20, v20
    v_rcp_f32 v21, v21
    v_rcp_f32 v22, v22
    v_rcp_f32_e64 v23, v23
    s_waitcnt lgkmcnt(4)
    v_pk_mul_f32 v[16:17], v[16:17], v[144:145]
    v_pk_mul_f32 v[18:19], v[18:19], v[146:147]
    v_pk_mul_f32 v[20:21], v[20:21], v[148:149]
    v_pk_mul_f32 v[22:23], v[22:23], v[150:151]
    s_cbranch_scc1 K2_last
    v_mfma_f32_32x32x16_bf16 v[136:151], v[168:171], v[220:223], 0
    s_waitcnt lgkmcnt(0)
    v_exp_f32 v8, v152
    v_exp_f32 v9, v153
    v_exp_f32_e64 v10, v154
    v_mfma_f32_32x32x16_bf16 v[136:151], v[172:175], v[224:227], v[136:151]
    s_barrier
    v_exp_f32 v11, v155
    v_exp_f32 v12, v156
    v_exp_f32 v13, v157
    v_exp_f32 v14, v158
    v_exp_f32 v15, v159
    v_add_u32 v3, s51, v3
    v_add_u32 v4, s51, v4
    v_pk_add_f32 v[8:9], v[8:9], s[54:55]
    v_pk_add_f32 v[10:11], v[10:11], s[54:55]
    v_pk_add_f32 v[12:13], v[12:13], s[54:55]
    v_pk_add_f32 v[14:15], v[14:15], s[54:55]
    v_mfma_f32_32x32x16_bf16 v[136:151], v[184:187], v[228:231], v[136:151]
    s_sub_i32 s51, 0, s51
    v_rcp_f32 v8, v8
    v_rcp_f32 v9, v9
    v_rcp_f32 v10, v10
    v_mfma_f32_32x32x16_bf16 v[136:151], v[188:191], v[236:239], v[136:151]
    s_sub_u32 s46, s46, 1
    v_rcp_f32 v11, v11
    v_rcp_f32 v12, v12
    v_rcp_f32 v13, v13
    v_rcp_f32 v14, v14
    v_rcp_f32 v15, v15
    v_cvt_pk_bf16_f32 v208, v16, v17
    v_cvt_pk_bf16_f32 v209, v18, v19
    v_cvt_pk_bf16_f32 v210, v20, v21
    v_cvt_pk_bf16_f32 v211, v22, v23
    v_pk_mul_f32 v[8:9], v[8:9], v[152:153]
    v_pk_mul_f32 v[10:11], v[10:11], v[154:155]
    v_pk_mul_f32 v[12:13], v[12:13], v[156:157]
    v_pk_mul_f32 v[14:15], v[14:15], v[158:159]
    v_mfma_f32_32x32x16_bf16 v[136:151], v[192:195], v[240:243], v[136:151]
    s_cmp_eq_u32 s46, 1
    v_exp_f32 v16, v160
    v_exp_f32 v17, v161
    v_exp_f32 v18, v162
    v_exp_f32 v19, v163
    v_exp_f32 v20, v164
    v_exp_f32 v21, v165
    v_exp_f32 v22, v166
    v_exp_f32_e64 v23, v167
    v_cvt_pk_bf16_f32 v212, v8, v9
    v_cvt_pk_bf16_f32 v213, v10, v11
    v_cvt_pk_bf16_f32 v214, v12, v13
    v_cvt_pk_bf16_f32 v215, v14, v15
    v_pk_add_f32 v[16:17], v[16:17], s[54:55]
    v_pk_add_f32 v[18:19], v[18:19], s[54:55]
    v_pk_add_f32 v[20:21], v[20:21], s[54:55]
    v_pk_add_f32 v[22:23], v[22:23], s[54:55]
    v_mfma_f32_32x32x16_bf16 v[104:119], v[204:207], v[196:199], v[104:119]
    ds_read_b128 v[168:171], v3 offset:0
    v_rcp_f32 v16, v16
    v_rcp_f32 v17, v17
    v_rcp_f32_e64 v18, v18
    v_mfma_f32_32x32x16_bf16 v[104:119], v[208:211], v[200:203], v[104:119]
    ds_read_b128 v[172:175], v3 offset:16
    v_rcp_f32 v19, v19
    v_rcp_f32 v20, v20
    v_rcp_f32 v21, v21
    v_rcp_f32 v22, v22
    v_rcp_f32_e64 v23, v23
    v_pk_mul_f32 v[16:17], v[16:17], v[160:161]
    v_pk_mul_f32 v[18:19], v[18:19], v[162:163]
    v_pk_mul_f32 v[20:21], v[20:21], v[164:165]
    v_pk_mul_f32 v[22:23], v[22:23], v[166:167]
    v_mfma_f32_32x32x16_bf16 v[152:167], v[176:179], v[220:223], 0
    ds_read_b128 v[176:179], v3 offset:32
    v_exp_f32 v8, v136
    v_exp_f32 v9, v137
    v_exp_f32_e64 v10, v138
    v_mfma_f32_32x32x16_bf16 v[152:167], v[180:183], v[224:227], v[152:167]
    ds_read_b128 v[180:183], v3 offset:48
    v_exp_f32 v11, v139
    v_exp_f32 v12, v140
    v_exp_f32 v13, v141
    v_exp_f32 v14, v142
    v_exp_f32_e64 v15, v143
    v_pk_add_f32 v[8:9], v[8:9], s[54:55]
    v_pk_add_f32 v[10:11], v[10:11], s[54:55]
    v_pk_add_f32 v[12:13], v[12:13], s[54:55]
    v_pk_add_f32 v[14:15], v[14:15], s[54:55]
    v_mfma_f32_32x32x16_bf16 v[152:167], v[184:187], v[232:235], v[152:167]
    ds_read_b128 v[184:187], v4 offset:4160
    v_rcp_f32 v8, v8
    v_rcp_f32 v9, v9
    v_rcp_f32_e64 v10, v10
    v_mfma_f32_32x32x16_bf16 v[152:167], v[188:191], v[244:247], v[152:167]
    ds_read_b128 v[188:191], v5 offset:0
    v_rcp_f32 v11, v11
    v_rcp_f32 v12, v12
    v_rcp_f32 v13, v13
    v_rcp_f32 v14, v14
    v_rcp_f32_e64 v15, v15
    v_cvt_pk_bf16_f32 v216, v16, v17
    v_cvt_pk_bf16_f32 v217, v18, v19
    v_cvt_pk_bf16_f32 v218, v20, v21
    v_cvt_pk_bf16_f32 v219, v22, v23
    v_pk_mul_f32 v[8:9], v[8:9], v[136:137]
    v_pk_mul_f32 v[10:11], v[10:11], v[138:139]
    v_pk_mul_f32 v[12:13], v[12:13], v[140:141]
    v_pk_mul_f32 v[14:15], v[14:15], v[142:143]
    v_mfma_f32_32x32x16_bf16 v[152:167], v[192:195], v[248:251], v[152:167]
    ds_read_b128 v[192:195], v5 offset:1024
    v_exp_f32 v16, v144
    v_exp_f32 v17, v145
    v_exp_f32_e64 v18, v146
    v_mfma_f32_32x32x16_bf16 v[120:135], v[212:215], v[196:199], v[120:135]
    ds_read_b128 v[196:199], v5 offset:2048
    v_exp_f32 v19, v147
    v_exp_f32 v20, v148
    v_exp_f32 v21, v149
    v_exp_f32 v22, v150
    v_exp_f32_e64 v23, v151
    v_cvt_pk_bf16_f32 v204, v8, v9
    v_cvt_pk_bf16_f32 v205, v10, v11
    v_cvt_pk_bf16_f32 v206, v12, v13
    v_cvt_pk_bf16_f32 v207, v14, v15
    v_pk_add_f32 v[16:17], v[16:17], s[54:55]
    v_pk_add_f32 v[18:19], v[18:19], s[54:55]
    v_pk_add_f32 v[20:21], v[20:21], s[54:55]
    v_pk_add_f32 v[22:23], v[22:23], s[54:55]
    v_mfma_f32_32x32x16_bf16 v[120:135], v[216:219], v[200:203], v[120:135]
    ds_read_b128 v[200:203], v5 offset:3072
    v_rcp_f32 v16, v16
    v_rcp_f32 v17, v17
    v_rcp_f32 v18, v18
    v_rcp_f32 v19, v19
    v_rcp_f32 v20, v20
    v_rcp_f32 v21, v21
    v_rcp_f32 v22, v22
    v_rcp_f32_e64 v23, v23
    s_waitcnt lgkmcnt(4)
    v_pk_mul_f32 v[16:17], v[16:17], v[144:145]
    v_pk_mul_f32 v[18:19], v[18:19], v[146:147]
    v_pk_mul_f32 v[20:21], v[20:21], v[148:149]
    v_pk_mul_f32 v[22:23], v[22:23], v[150:151]
    s_cbranch_scc1 K2_last
    v_mfma_f32_32x32x16_bf16 v[136:151], v[168:171], v[220:223], 0
    s_waitcnt lgkmcnt(0)
    v_exp_f32 v8, v152
    v_exp_f32 v9, v153
    v_exp_f32_e64 v10, v154
    v_mfma_f32_32x32x16_bf16 v[136:151], v[172:175], v[224:227], v[136:151]
    s_barrier
    v_exp_f32 v11, v155
    v_exp_f32 v12, v156
    v_exp_f32 v13, v157
    v_exp_f32 v14, v158
    v_exp_f32 v15, v159
    v_pk_add_f32 v[8:9], v[8:9], s[54:55]
    v_pk_add_f32 v[10:11], v[10:11], s[54:55]
    v_pk_add_f32 v[12:13], v[12:13], s[54:55]
    v_pk_add_f32 v[14:15], v[14:15], s[54:55]
    v_mfma_f32_32x32x16_bf16 v[136:151], v[184:187], v[228:231], v[136:151]
    v_rcp_f32 v8, v8
    v_rcp_f32 v9, v9
    v_rcp_f32_e64 v10, v10
    v_mfma_f32_32x32x16_bf16 v[136:151], v[188:191], v[236:239], v[136:151]
    s_sub_u32 s46, s46, 1
    v_rcp_f32 v11, v11
    v_rcp_f32 v12, v12
    v_rcp_f32 v13, v13
    v_rcp_f32 v14, v14
    v_rcp_f32 v15, v15
    v_cvt_pk_bf16_f32 v208, v16, v17
    v_cvt_pk_bf16_f32 v209, v18, v19
    v_cvt_pk_bf16_f32 v210, v20, v21
    v_cvt_pk_bf16_f32 v211, v22, v23
    v_pk_mul_f32 v[8:9], v[8:9], v[152:153]
    v_pk_mul_f32 v[10:11], v[10:11], v[154:155]
    v_pk_mul_f32 v[12:13], v[12:13], v[156:157]
    v_pk_mul_f32 v[14:15], v[14:15], v[158:159]
    v_mfma_f32_32x32x16_bf16 v[136:151], v[192:195], v[240:243], v[136:151]
    s_cmp_eq_u32 s46, 1
    v_exp_f32 v16, v160
    v_exp_f32 v17, v161
    v_exp_f32 v18, v162
    v_exp_f32 v19, v163
    v_exp_f32 v20, v164
    v_exp_f32 v21, v165
    v_exp_f32 v22, v166
    v_exp_f32_e64 v23, v167
    v_cvt_pk_bf16_f32 v212, v8, v9
    v_cvt_pk_bf16_f32 v213, v10, v11
    v_cvt_pk_bf16_f32 v214, v12, v13
    v_cvt_pk_bf16_f32 v215, v14, v15
    v_pk_add_f32 v[16:17], v[16:17], s[54:55]
    v_pk_add_f32 v[18:19], v[18:19], s[54:55]
    v_pk_add_f32 v[20:21], v[20:21], s[54:55]
    v_pk_add_f32 v[22:23], v[22:23], s[54:55]
    v_mfma_f32_32x32x16_bf16 v[104:119], v[204:207], v[196:199], v[104:119]
    ds_read_b128 v[168:171], v3 offset:20736
    v_rcp_f32 v16, v16
    v_rcp_f32 v17, v17
    v_rcp_f32_e64 v18, v18
    v_mfma_f32_32x32x16_bf16 v[104:119], v[208:211], v[200:203], v[104:119]
    ds_read_b128 v[172:175], v3 offset:20752
    v_rcp_f32 v19, v19
    v_rcp_f32 v20, v20
    v_rcp_f32 v21, v21
    v_rcp_f32 v22, v22
    v_rcp_f32_e64 v23, v23
    v_pk_mul_f32 v[16:17], v[16:17], v[160:161]
    v_pk_mul_f32 v[18:19], v[18:19], v[162:163]
    v_pk_mul_f32 v[20:21], v[20:21], v[164:165]
    v_pk_mul_f32 v[22:23], v[22:23], v[166:167]
    s_branch K2_loop
K2_last:
    s_cmp_eq_u32 s47, 0
    s_cbranch_scc1 K2_last2
    s_waitcnt lgkmcnt(0)
    s_barrier
    s_sub_u32 s47, s47, 1
K2_last2:
    v_exp_f32 v8, v152
    v_exp_f32 v9, v153
    v_exp_f32 v10, v154
    v_exp_f32 v11, v155
    v_exp_f32 v12, v156
    v_exp_f32 v13, v157
    v_exp_f32 v14, v158
    v_exp_f32 v15, v159
    v_cvt_pk_bf16_f32 v208, v16, v17
    v_cvt_pk_bf16_f32 v209, v18, v19
    v_cvt_pk_bf16_f32 v210, v20, v21
    v_cvt_pk_bf16_f32 v211, v22, v23
    v_pk_add_f32 v[8:9], v[8:9], s[54:55]
    v_pk_add_f32 v[10:11], v[10:11], s[54:55]
    v_pk_add_f32 v[12:13], v[12:13], s[54:55]
    v_pk_add_f32 v[14:15], v[14:15], s[54:55]
    s_waitcnt lgkmcnt(0)
    v_mfma_f32_32x32x16_bf16 v[104:119], v[204:207], v[196:199], v[104:119]
    v_rcp_f32 v8, v8
    v_rcp_f32 v9, v9
    v_rcp_f32 v10, v10
    v_mfma_f32_32x32x16_bf16 v[104:119], v[208:211], v[200:203], v[104:119]
    v_rcp_f32 v11, v11
    v_rcp_f32 v12, v12
    v_rcp_f32 v13, v13
    v_rcp_f32 v14, v14
    v_rcp_f32 v15, v15
    v_pk_mul_f32 v[8:9], v[8:9], v[152:153]
    v_pk_mul_f32 v[10:11], v[10:11], v[154:155]
    v_pk_mul_f32 v[12:13], v[12:13], v[156:157]
    v_pk_mul_f32 v[14:15], v[14:15], v[158:159]
    v_exp_f32 v16, v160
    v_exp_f32 v17, v161
    v_exp_f32 v18, v162
    v_exp_f32 v19, v163
    v_exp_f32 v20, v164
    v_exp_f32 v21, v165
    v_exp_f32 v22, v166
    v_exp_f32 v23, v167
    v_cvt_pk_bf16_f32 v212, v8, v9
    v_cvt_pk_bf16_f32 v213, v10, v11
    v_cvt_pk_bf16_f32 v214, v12, v13
    v_cvt_pk_bf16_f32 v215, v14, v15
    v_pk_add_f32 v[16:17], v[16:17], s[54:55]
    v_pk_add_f32 v[18:19], v[18:19], s[54:55]
    v_pk_add_f32 v[20:21], v[20:21], s[54:55]
    v_pk_add_f32 v[22:23], v[22:23], s[54:55]
    v_mfma_f32_32x32x16_bf16 v[120:135], v[212:215], v[196:199], v[120:135]
    v_rcp_f32 v16, v16
    v_rcp_f32 v17, v17
    v_rcp_f32 v18, v18
    v_rcp_f32 v19, v19
    v_rcp_f32 v20, v20
    v_rcp_f32 v21, v21
    v_rcp_f32 v22, v22
    v_rcp_f32 v23, v23
    v_pk_mul_f32 v[16:17], v[16:17], v[160:161]
    v_pk_mul_f32 v[18:19], v[18:19], v[162:163]
    v_pk_mul_f32 v[20:21], v[20:21], v[164:165]
    v_pk_mul_f32 v[22:23], v[22:23], v[166:167]
    v_cvt_pk_bf16_f32 v216, v16, v17
    v_cvt_pk_bf16_f32 v217, v18, v19
    v_cvt_pk_bf16_f32 v218, v20, v21
    v_cvt_pk_bf16_f32 v219, v22, v23
    s_nop 1
    v_mfma_f32_32x32x16_bf16 v[120:135], v[216:219], v[200:203], v[120:135]
K2_crest:
    s_cmp_eq_u32 s47, 0
    s_cbranch_scc1 K2_crest3
K2_crest2:
    s_barrier
    s_sub_u32 s47, s47, 1
    s_cmp_lg_u32 s47, 0
    s_cbranch_scc1 K2_crest2
K2_crest3:
    s_cmp_ge_u32 s48, s45
    s_cbranch_scc1 K2_fin
    s_barrier
    v_mov_b32 v196, 0
    v_mov_b32 v197, 0
    v_mov_b32 v198, 0
    v_mov_b32 v199, 0
    v_mov_b32 v200, 0
    v_mov_b32 v201, 0
    v_mov_b32 v202, 0
    v_mov_b32 v203, 0
    ds_write_b128 v5, v[196:199] offset:0
    ds_write_b128 v5, v[196:199] offset:1024
    ds_write_b128 v5, v[196:199] offset:2048
    ds_write_b128 v5, v[196:199] offset:3072
    ds_write_b128 v5, v[196:199] offset:4096
    ds_write_b128 v5, v[196:199] offset:5120
    ds_write_b128 v5, v[196:199] offset:6144
    ds_write_b128 v5, v[196:199] offset:7168
    s_waitcnt lgkmcnt(0)
    s_barrier
    s_branch K2_cpass
K2_fin:
    s_mov_b32 s56, 0xbf317218
    s_mov_b32 s57, 0xbf317218
    v_and_b32 v3, 31, v1
    v_mul_u32_u24 v3, 144, v3
    v_and_b32 v4, 32, v1
    v_lshl_add_u32 v3, v4, 1, v3
    v_add_u32 v3, s32, v3
    v_lshrrev_b32 v4, 3, v1
    v_add_lshl_u32 v4, v4, v1, 4
    v_add_u32 v4, s32, v4
    v_pk_mul_f32 v[104:105], v[104:105], s[56:57]
    v_pk_mul_f32 v[106:107], v[106:107], s[56:57]
    v_pk_mul_f32 v[108:109], v[108:109], s[56:57]
    v_pk_mul_f32 v[110:111], v[110:111], s[56:57]
    v_pk_mul_f32 v[112:113], v[112:113], s[56:57]
    v_pk_mul_f32 v[114:115], v[114:115], s[56:57]
    v_pk_mul_f32 v[116:117], v[116:117], s[56:57]
    v_pk_mul_f32 v[118:119], v[118:119], s[56:57]
    v_pk_mul_f32 v[120:121], v[120:121], s[56:57]
    v_pk_mul_f32 v[122:123], v[122:123], s[56:57]
    v_pk_mul_f32 v[124:125], v[124:125], s[56:57]
    v_pk_mul_f32 v[126:127], v[126:127], s[56:57]
    v_pk_mul_f32 v[128:129], v[128:129], s[56:57]
    v_pk_mul_f32 v[130:131], v[130:131], s[56:57]
    v_pk_mul_f32 v[132:133], v[132:133], s[56:57]
    v_pk_mul_f32 v[134:135], v[134:135], s[56:57]
    s_waitcnt vmcnt(0)
    v_mfma_f32_32x32x16_bf16 v[136:151], v[40:43], v[24:27], 0
    v_cvt_pk_bf16_f32 v204, v104, v105
    v_cvt_pk_bf16_f32 v205, v106, v107
    v_cvt_pk_bf16_f32 v206, v108, v109
    v_cvt_pk_bf16_f32 v207, v110, v111
    v_mfma_f32_32x32x16_bf16 v[136:151], v[44:47], v[28:31], v[136:151]
    v_cvt_pk_bf16_f32 v208, v112, v113
    v_cvt_pk_bf16_f32 v209, v114, v115
    v_cvt_pk_bf16_f32 v210, v116, v117
    v_cvt_pk_bf16_f32 v211, v118, v119
    v_mfma_f32_32x32x16_bf16 v[136:151], v[48:51], v[32:35], v[136:151]
    v_cvt_pk_bf16_f32 v212, v120, v121
    v_cvt_pk_bf16_f32 v213, v122, v123
    v_cvt_pk_bf16_f32 v214, v124, v125
    v_cvt_pk_bf16_f32 v215, v126, v127
    v_mfma_f32_32x32x16_bf16 v[136:151], v[52:55], v[36:39], v[136:151]
    v_cvt_pk_bf16_f32 v216, v128, v129
    v_cvt_pk_bf16_f32 v217, v130, v131
    v_cvt_pk_bf16_f32 v218, v132, v133
    v_cvt_pk_bf16_f32 v219, v134, v135
    s_mov_b32 s56, 0xbfb8aa3b
    s_mov_b32 s57, 0xbfb8aa3b
    v_mfma_f32_32x32x16_bf16 v[136:151], v[56:59], v[204:207], v[136:151]
    v_mfma_f32_32x32x16_bf16 v[136:151], v[60:63], v[208:211], v[136:151]
    v_mfma_f32_32x32x16_bf16 v[136:151], v[64:67], v[212:215], v[136:151]
    v_mfma_f32_32x32x16_bf16 v[136:151], v[68:71], v[216:219], v[136:151]
    v_mfma_f32_32x32x16_bf16 v[152:167], v[72:75], v[24:27], 0
    v_mfma_f32_32x32x16_bf16 v[152:167], v[76:79], v[28:31], v[152:167]
    s_nop 7
    s_nop 1
    v_pk_mul_f32 v[8:9], v[136:137], s[56:57]
    v_pk_mul_f32 v[10:11], v[138:139], s[56:57]
    v_pk_mul_f32 v[12:13], v[140:141], s[56:57]
    v_pk_mul_f32 v[14:15], v[142:143], s[56:57]
    v_pk_mul_f32 v[16:17], v[144:145], s[56:57]
    v_pk_mul_f32 v[18:19], v[146:147], s[56:57]
    v_pk_mul_f32 v[20:21], v[148:149], s[56:57]
    v_pk_mul_f32 v[22:23], v[150:151], s[56:57]
    v_mfma_f32_32x32x16_bf16 v[152:167], v[80:83], v[32:35], v[152:167]
    v_exp_f32 v8, v8
    v_exp_f32 v9, v9
    v_exp_f32 v10, v10
    v_mfma_f32_32x32x16_bf16 v[152:167], v[84:87], v[36:39], v[152:167]
    v_exp_f32 v11, v11
    v_exp_f32 v12, v12
    v_exp_f32 v13, v13
    v_exp_f32 v14, v14
    v_exp_f32 v15, v15
    v_pk_add_f32 v[8:9], v[8:9], s[54:55]
    v_pk_add_f32 v[10:11], v[10:11], s[54:55]
    v_pk_add_f32 v[12:13], v[12:13], s[54:55]
    v_pk_add_f32 v[14:15], v[14:15], s[54:55]
    v_mfma_f32_32x32x16_bf16 v[152:167], v[88:91], v[204:207], v[152:167]
    v_exp_f32 v16, v16
    v_exp_f32 v17, v17
    v_exp_f32 v18, v18
    v_mfma_f32_32x32x16_bf16 v[152:167], v[92:95], v[208:211], v[152:167]
    v_exp_f32 v19, v19
    v_exp_f32 v20, v20
    v_exp_f32 v21, v21
    v_exp_f32 v22, v22
    v_exp_f32 v23, v23
    v_pk_add_f32 v[16:17], v[16:17], s[54:55]
    v_pk_add_f32 v[18:19], v[18:19], s[54:55]
    v_pk_add_f32 v[20:21], v[20:21], s[54:55]
    v_pk_add_f32 v[22:23], v[22:23], s[54:55]
    v_mfma_f32_32x32x16_bf16 v[152:167], v[96:99], v[212:215], v[152:167]
    v_rcp_f32 v8, v8
    v_rcp_f32 v9, v9
    v_rcp_f32 v10, v10
    v_mfma_f32_32x32x16_bf16 v[152:167], v[100:103], v[216:219], v[152:167]
    v_rcp_f32 v11, v11
    v_rcp_f32 v12, v12
    v_rcp_f32 v13, v13
    v_rcp_f32 v14, v14
    v_rcp_f32 v15, v15
    v_pk_mul_f32 v[8:9], v[8:9], v[136:137]
    v_pk_mul_f32 v[10:11], v[10:11], v[138:139]
    v_pk_mul_f32 v[12:13], v[12:13], v[140:141]
    v_pk_mul_f32 v[14:15], v[14:15], v[142:143]
    v_rcp_f32 v16, v16
    v_rcp_f32 v17, v17
    v_rcp_f32 v18, v18
    v_rcp_f32 v19, v19
    v_rcp_f32 v20, v20
    v_rcp_f32 v21, v21
    v_rcp_f32 v22, v22
    v_rcp_f32 v23, v23
    v_cvt_pk_bf16_f32 v104, v8, v9
    v_cvt_pk_bf16_f32 v105, v10, v11
    v_cvt_pk_bf16_f32 v106, v12, v13
    v_cvt_pk_bf16_f32 v107, v14, v15
    ds_write_b128 v3, v[104:107] offset:0
    v_pk_mul_f32 v[16:17], v[16:17], v[144:145]
    v_pk_mul_f32 v[18:19], v[18:19], v[146:147]
    v_pk_mul_f32 v[20:21], v[20:21], v[148:149]
    v_pk_mul_f32 v[22:23], v[22:23], v[150:151]
    v_pk_mul_f32 v[8:9], v[152:153], s[56:57]
    v_pk_mul_f32 v[10:11], v[154:155], s[56:57]
    v_pk_mul_f32 v[12:13], v[156:157], s[56:57]
    v_pk_mul_f32 v[14:15], v[158:159], s[56:57]
    v_cvt_pk_bf16_f32 v108, v16, v17
    v_cvt_pk_bf16_f32 v109, v18, v19
    v_cvt_pk_bf16_f32 v110, v20, v21
    v_cvt_pk_bf16_f32 v111, v22, v23
    ds_write_b128 v3, v[108:111] offset:16
    v_pk_mul_f32 v[16:17], v[160:161], s[56:57]
    v_pk_mul_f32 v[18:19], v[162:163], s[56:57]
    v_pk_mul_f32 v[20:21], v[164:165], s[56:57]
    v_pk_mul_f32 v[22:23], v[166:167], s[56:57]
    v_exp_f32 v8, v8
    v_exp_f32 v9, v9
    v_exp_f32 v10, v10
    v_exp_f32 v11, v11
    v_exp_f32 v12, v12
    v_exp_f32 v13, v13
    v_exp_f32 v14, v14
    v_exp_f32 v15, v15
    v_pk_add_f32 v[8:9], v[8:9], s[54:55]
    v_pk_add_f32 v[10:11], v[10:11], s[54:55]
    v_pk_add_f32 v[12:13], v[12:13], s[54:55]
    v_pk_add_f32 v[14:15], v[14:15], s[54:55]
    v_exp_f32 v16, v16
    v_exp_f32 v17, v17
    v_exp_f32 v18, v18
    v_exp_f32 v19, v19
    v_exp_f32 v20, v20
    v_exp_f32 v21, v21
    v_exp_f32 v22, v22
    v_exp_f32 v23, v23
    v_pk_add_f32 v[16:17], v[16:17], s[54:55]
    v_pk_add_f32 v[18:19], v[18:19], s[54:55]
    v_pk_add_f32 v[20:21], v[20:21], s[54:55]
    v_pk_add_f32 v[22:23], v[22:23], s[54:55]
    v_rcp_f32 v8, v8
    v_rcp_f32 v9, v9
    v_rcp_f32 v10, v10
    v_rcp_f32 v11, v11
    v_rcp_f32 v12, v12
    v_rcp_f32 v13, v13
    v_rcp_f32 v14, v14
    v_rcp_f32 v15, v15
    v_pk_mul_f32 v[8:9], v[8:9], v[152:153]
    v_pk_mul_f32 v[10:11], v[10:11], v[154:155]
    v_pk_mul_f32 v[12:13], v[12:13], v[156:157]
    v_pk_mul_f32 v[14:15], v[14:15], v[158:159]
    v_rcp_f32 v16, v16
    v_rcp_f32 v17, v17
    v_rcp_f32 v18, v18
    v_rcp_f32 v19, v19
    v_rcp_f32 v20, v20
    v_rcp_f32 v21, v21
    v_rcp_f32 v22, v22
    v_rcp_f32 v23, v23
    v_cvt_pk_bf16_f32 v112, v8, v9
    v_cvt_pk_bf16_f32 v113, v10, v11
    v_cvt_pk_bf16_f32 v114, v12, v13
    v_cvt_pk_bf16_f32 v115, v14, v15
    ds_write_b128 v3, v[112:115] offset:32
    v_pk_mul_f32 v[16:17], v[16:17], v[160:161]
    v_pk_mul_f32 v[18:19], v[18:19], v[162:163]
    v_pk_mul_f32 v[20:21], v[20:21], v[164:165]
    v_pk_mul_f32 v[22:23], v[22:23], v[166:167]
    v_cvt_pk_bf16_f32 v116, v16, v17
    v_cvt_pk_bf16_f32 v117, v18, v19
    v_cvt_pk_bf16_f32 v118, v20, v21
    v_cvt_pk_bf16_f32 v119, v22, v23
    ds_write_b128 v3, v[116:119] offset:48
    ds_read_b128 v[168:171], v4 offset:0
    ds_read_b128 v[172:175], v4 offset:1152
    ds_read_b128 v[176:179], v4 offset:2304
    ds_read_b128 v[180:183], v4 offset:3456
    s_waitcnt lgkmcnt(3)
    buffer_store_dwordx4 v[168:171], v2, s[20:23], 0 offen offset:0 sc1
    s_waitcnt lgkmcnt(2)
    buffer_store_dwordx4 v[172:175], v2, s[20:23], 0 offen offset:1024 sc1
    s_waitcnt lgkmcnt(1)
    buffer_store_dwordx4 v[176:179], v2, s[20:23], 0 offen offset:2048 sc1
    s_waitcnt lgkmcnt(0)
    buffer_store_dwordx4 v[180:183], v2, s[20:23], 0 offen offset:3072 sc1
K2_end:
    s_endpgm
.section .rodata,"a"
.p2align 6
.amdhsa_kernel standalone__mpnn_edge_mlp__graph_kernel
  .amdhsa_next_free_vgpr 252
  .amdhsa_next_free_sgpr 102
  .amdhsa_accum_offset 252
  .amdhsa_group_segment_fixed_size 0
  .amdhsa_kernarg_size 72
  .amdhsa_user_sgpr_count 2
  .amdhsa_user_sgpr_kernarg_segment_ptr 1
  .amdhsa_system_sgpr_workgroup_id_x 1
.end_amdhsa_kernel
```
